```python
import torch

def _softmax(x, axis=-1):
    return torch.softmax(x, dim=axis)
def _gelu(x):
    return torch.nn.functional.gelu(x, approximate="tanh")
def _silu(x):
    return torch.nn.functional.silu(x)
def _sigmoid(x):
    return torch.sigmoid(x)
def _layernorm(x, axis=-1, eps=1e-5):
    m = x.mean(dim=axis, keepdim=True)
    v = x.var(dim=axis, keepdim=True, unbiased=False)
    return (x - m) / torch.sqrt(v + eps)
def _scatter_add(tgt, idx, src, axis=0):
    return tgt.clone().index_add_(axis, idx, src)
def _segment_sum(src, seg, n):
    out = torch.zeros((n,) + src.shape[1:], dtype=src.dtype)
    return out.index_add_(0, seg, src)
def _pad(x, pw):
    flat = tuple(v for pair in reversed(pw) for v in pair)
    return torch.nn.functional.pad(x, flat)

kernel_name = 'recurrent_scan__ssm_conv_s4d__moe_arch_mod__prompt'

def setup_inputs():

    _w = (lambda a: (lambda t: t.to(torch.bfloat16) if t.is_floating_point() else t)(torch.as_tensor(a)))
    def _A_setup():
        Bsz, L, D, N = 1, 2048, 512, 128
        return {
            "u": _w((lambda *s: torch.randn(*s, dtype=torch.bfloat16) * 0.05)(Bsz, L, D)),
            "log_A_real": _w((lambda *s: torch.randn(*s, dtype=torch.bfloat16) * 3.2)(D, N) * 0.5),
            "A_imag": _w((lambda *s: torch.randn(*s, dtype=torch.bfloat16) * 0.05)(D, N) * 3.14),
            "C_real": _w((lambda *s: torch.randn(*s, dtype=torch.bfloat16) * 0.1)(D, N) / N ** 0.5),
            "C_imag": _w((lambda *s: torch.randn(*s, dtype=torch.bfloat16) * 0.1)(D, N) / N ** 0.5),
            "log_dt": _w((lambda *s: torch.randn(*s, dtype=torch.bfloat16) * 0.05)(D) * 0.5 - 4.0),
            "D_skip": _w((lambda *s: torch.randn(*s, dtype=torch.bfloat16) * 0.05)(D)),
        }
    _A_in = _A_setup()

    def _B_setup():
        B, S, D, F, C = 1, 2048, 512, 1376, 1
        return {
            "x": _w((lambda *s: torch.randn(*s, dtype=torch.bfloat16) * 0.05)(B, S, D)),
            "w_r": _w((lambda *s: torch.randn(*s, dtype=torch.bfloat16) * 3.2)(D)),
            "w_gate": _w((lambda *s: torch.randn(*s, dtype=torch.bfloat16) * 0.1)(D, F)),
            "w_up": _w((lambda *s: torch.randn(*s, dtype=torch.bfloat16) * 0.1)(D, F)),
            "w_down": _w((lambda *s: torch.randn(*s, dtype=torch.bfloat16) * 0.1)(F, D)),
        }
    _B_in = _B_setup()

    return {
        "A_u": _A_in["u"],
        "A_log_A_real": _A_in["log_A_real"],
        "A_A_imag": _A_in["A_imag"],
        "A_C_real": _A_in["C_real"],
        "A_C_imag": _A_in["C_imag"],
        "A_log_dt": _A_in["log_dt"],
        "A_D_skip": _A_in["D_skip"],
        "B_x": _B_in["x"],
        "B_w_r": _B_in["w_r"],
        "B_w_gate": _B_in["w_gate"],
        "B_w_up": _B_in["w_up"],
        "B_w_down": _B_in["w_down"],
    }

def reference(A_u, A_log_A_real, A_A_imag, A_C_real, A_C_imag, A_log_dt, A_D_skip, B_x, B_w_r, B_w_gate, B_w_up, B_w_down):
    def _A_ref(u, log_A_real, A_imag, C_real, C_imag, log_dt, D_skip):
        L = u.shape[1]
        dt = torch.exp(log_dt)
        A = -torch.exp(log_A_real) + 1j * A_imag
        C = (C_real + 1j * C_imag) * dt[:, None]
        pos = (lambda x, dt: x.to(dt))(torch.arange(L), log_dt.dtype)
        P = torch.exp((A * dt[:, None])[:, :, None] * pos[None, None, :])
        K = 2.0 * torch.einsum("dn,dnl->dl", C, P).real
        L2 = 2 * L
        u_t = (lambda x, *d: x.permute(*d))(u, 0, 2, 1)
        Kf = (lambda x, *a, **k: torch.fft.rfft(x.float(), *a, **k))(K, L2)
        Uf = (lambda x, *a, **k: torch.fft.rfft(x.float(), *a, **k))(u_t, L2)
        y = (lambda x, *a, **k: torch.fft.irfft(x, *a, **k).to(torch.bfloat16))(Uf * Kf[None, :, :], L2)[:, :, :L]
        y = (lambda x, *d: x.permute(*d))(y, 0, 2, 1)
        return y + u * D_skip[None, None, :]

    def _B_ref(x, w_r, w_gate, w_up, w_down):
        B, S, D = x.shape
        C = 1
        r = x @ w_r
        idx = torch.argsort(-r, axis=-1)[:, :C]
        idx_e = (lambda x, n, axis: torch.repeat_interleave(x, n, dim=axis))(idx.reshape(B, C, 1), D, axis=2)
        x_sel = (lambda x, i, axis: torch.take_along_dim(x, i, dim=axis))(x, idx_e, axis=1)
        g = _silu(x_sel @ w_gate)
        u = x_sel @ w_up
        y = (g * u) @ w_down
        r_sel = _sigmoid((lambda x, i, axis: torch.take_along_dim(x, i, dim=axis))(r, idx, axis=1))
        y = y * r_sel.reshape(B, C, 1)
        b_off = (torch.arange(B) * S).reshape(B, 1)
        flat_idx = (idx + b_off).reshape(B * C)
        zero = (x * 0.0).reshape(B * S, D)
        upd = _scatter_add(zero, flat_idx, y.reshape(B * C, D), axis=0)
        return x + upd.reshape(B, S, D)

    x = A_u
    xn = _layernorm(x, axis=-1)
    s = _A_ref(xn, A_log_A_real, A_A_imag, A_C_real, A_C_imag, A_log_dt, A_D_skip)
    g = _silu(_B_ref(xn, B_w_r, B_w_gate, B_w_up, B_w_down))
    return x + s * g
```

```asm
; @launch grid=(256,1,1) block=(512,1,1) lds=163840
.amdgcn_target "amdgcn-amd-amdhsa--gfx950"
.text
.globl recurrent_scan__ssm_conv_s4d__moe_arch_mod__prompt_kernel
.p2align 8
.type recurrent_scan__ssm_conv_s4d__moe_arch_mod__prompt_kernel,@function
recurrent_scan__ssm_conv_s4d__moe_arch_mod__prompt_kernel:
    s_cmp_ge_u32 s2, 256
    s_cbranch_scc1 END
    s_load_dwordx16 s[4:19], s[0:1], 0
    s_load_dwordx8 s[20:27], s[0:1], 64
    s_load_dwordx2 s[28:29], s[0:1], 96
    s_load_dwordx2 s[32:33], s[0:1], 112
    s_getpc_b64 s[76:77]
PCL:
    v_lshlrev_b32 v48, 7, v0
    v_cmp_gt_u32 vcc, END-PCL, v48
    s_cbranch_vccz NOPF
    v_min_u32 v48, END-PCL, v48
    v_mov_b32 v49, s77
    v_add_co_u32 v48, vcc, s76, v48
    s_nop 1
    v_addc_co_u32 v49, vcc, 0, v49, vcc
    global_load_dword v48, v[48:49], off
NOPF:
    v_readfirstlane_b32 s3, v0
    s_and_b32 s64, s2, 7
    s_lshr_b32 s65, s2, 4
    s_lshl_b32 s37, s64, 4
    s_add_u32 s37, s37, s65
    s_lshl_b32 s36, s37, 3
    s_bfe_u32 s38, s2, 0x10003
    s_lshr_b32 s66, s2, 6
    s_lshl_b32 s66, s66, 3
    s_add_u32 s66, s66, s64
    s_lshl_b32 s66, s66, 3
    s_bfe_u32 s67, s2, 0x30003
    s_add_u32 s39, s66, s67
    s_cmp_lt_u32 s39, 172
    s_cselect_b32 s43, 2752, 0
    s_cselect_b32 s39, s39, 0
    s_cselect_b32 s68, 2, 0
    s_lshr_b32 s3, s3, 6
    s_lshr_b32 s49, s3, 1
    s_and_b32 s50, s3, 1
    s_lshr_b32 s51, s3, 2
    s_xor_b32 s75, s51, s50
    s_xor_b32 s51, s51, s38
    s_lshl_b32 s69, s2, 13
    s_lshl_b32 s70, s36, 7
    s_lshl_b32 s71, s39, 4
    s_lshl_b32 s72, s39, 13
    s_add_u32 s72, s72, 4096
    v_lshlrev_b32 v27, 4, v0
    v_and_b32 v1, 63, v0
    v_add_u32 v104, s69, v27
    v_lshl_add_u32 v105, v0, 1, s70
    v_lshlrev_b32 v106, 4, v1
    v_mul_u32_u24 v45, s43, v0
    v_add_u32 v45, s71, v45
    v_mul_u32_u24 v46, s68, v0
    v_add_u32 v46, s72, v46
    v_mov_b32 v100, 0
    v_mov_b32 v101, 0
    v_mov_b32 v102, 0
    v_mov_b32 v103, 0
    s_waitcnt lgkmcnt(0)
    global_load_dwordx4 v[92:95], v104, s[4:5]
    global_load_short_d16_hi v100, v105, s[6:7]
    global_load_short_d16_hi v101, v105, s[8:9]
    global_load_short_d16_hi v102, v105, s[10:11]
    global_load_short_d16_hi v103, v105, s[12:13]
    global_load_dwordx4 v[96:99], v106, s[20:21]
    s_load_dword s48, s[32:33], 0
    s_load_dwordx2 s[44:45], s[14:15], s36
    s_load_dwordx2 s[46:47], s[16:17], s36
    s_mov_b32 s30, 2097152
    s_mov_b32 s31, 0x00020000
    s_mov_b32 s34, 268435456
    s_mov_b32 s35, 0x00020000
    v_mov_b32 v36, 0
    v_mov_b32 v37, 0
    v_mov_b32 v38, 0
    v_mov_b32 v39, 0
    v_mov_b32 v40, 0
    v_mov_b32 v41, 0
    v_mov_b32 v42, 0
    v_mov_b32 v43, 0
    v_mov_b32 v44, 0
    v_and_b32 v104, 15, v0
    v_lshrrev_b32 v105, 4, v1
    v_lshlrev_b32 v108, 3, v105
    v_sub_u32 v106, v104, v108
    v_add_u32 v106, 16, v106
    v_and_b32 v107, 0xffff, v106
    v_lshl_or_b32 v107, v106, 16, v107
    v_lshrrev_b32 v108, 7, v0
    v_and_b32 v109, 127, v0
    v_mul_u32_u24 v108, 4608, v108
    v_lshl_add_u32 v108, v109, 2, v108
    v_add_u32 v108, 120384, v108
    v_mov_b32 v110, 0
    ds_write_b32 v108, v110
    v_and_b32 v109, 15, v0
    v_lshlrev_b32 v109, 2, v109
    v_add_u32 v109, 163584, v109
    ds_write_b32 v109, v110
    s_lshl_b32 s70, s37, 15
    s_add_u32 s70, s70, 1048576
    s_lshl_b32 s73, s51, 13
    s_add_u32 s56, s70, s73
    s_add_u32 s58, s56, 16384
    s_xor_b32 s73, s73, 8192
    s_add_u32 s57, s70, s73
    s_add_u32 s59, s57, 16384
    s_lshr_b32 s70, s49, 1
    s_mul_i32 s70, s70, 60192
    s_and_b32 s73, s49, 1
    s_lshl_b32 s73, s73, 9
    s_add_u32 s70, s70, s73
    s_lshl_b32 s73, s50, 8
    s_add_u32 s76, s70, s73
    v_lshlrev_b32 v108, 4, v105
    v_add_u32 v108, s70, v108
    v_mul_u32_u24 v109, 1056, v104
    v_add_u32 v84, v108, v109
    v_add_u32 v109, 48, v104
    v_cmp_eq_u32 vcc, 9, v104
    s_nop 1
    v_cndmask_b32 v109, v109, 40, vcc
    v_cmp_lt_u32 vcc, 9, v104
    s_nop 1
    v_cndmask_b32 v109, v109, 48, vcc
    v_mul_u32_u24 v109, 1056, v109
    v_add_u32 v85, v108, v109
    s_mov_b32 s64, 65536
    s_mov_b32 s65, 196610
    s_mov_b32 s66, 327684
    s_mov_b32 s67, 458758
    v_pk_sub_u16 v2, v107, s64
    v_pk_sub_u16 v3, v107, s65
    v_pk_sub_u16 v4, v107, s66
    v_pk_sub_u16 v5, v107, s67
    v_pk_ashrrev_i16 v2, 15, v2 op_sel_hi:[0,1]
    v_pk_ashrrev_i16 v3, 15, v3 op_sel_hi:[0,1]
    v_pk_ashrrev_i16 v4, 15, v4 op_sel_hi:[0,1]
    v_pk_ashrrev_i16 v5, 15, v5 op_sel_hi:[0,1]
    s_mul_i32 s68, s49, 6192
    s_add_u32 s68, s68, 138816
    s_mov_b32 s69, 1548
    v_sub_u32 v108, 287, v106
    v_and_b32 v6, 1, v108
    v_lshlrev_b32 v6, 1, v6
    v_bfe_u32 v109, v108, 1, 2
    v_and_b32 v108, -2, v108
    s_lshl_b32 s70, s75, 8
    s_sub_u32 s70, s68, s70
    s_sub_u32 s70, s70, 512
    v_lshl_add_u32 v108, v108, 1, s70
    v_mad_u32_u24 v17, v109, s69, v108
    s_mul_i32 s70, s3, 1056
    s_add_u32 s70, s70, 138816
    v_lshl_add_u32 v108, v1, 4, s70
    v_and_b32 v88, 7, v0
    v_mul_u32_u24 v109, 1056, v88
    v_and_b32 v89, -8, v0
    v_add_u32 v89, 138816, v89
    v_add_u32 v111, 139840, v109
    v_add_u32 v109, v89, v109
    v_lshrrev_b32 v89, 3, v0
    v_lshlrev_b32 v89, 15, v89
    v_lshl_add_u32 v110, v88, 4, v89
    s_lshl_b32 s73, s2, 7
    s_add_u32 s73, s73, 1048576
    s_add_u32 s74, s73, 2097152
    s_waitcnt lgkmcnt(0)
    s_lshr_b32 s40, s48, 16
    s_add_u32 s40, s40, 0x4e37
    s_and_b32 s40, s40, 0xffff
    s_xor_b32 s41, s40, 0x5a5a
    s_lshl_b32 s42, s41, 16
    s_or_b32 s42, s42, s40
    s_lshl_b32 s52, s46, 16
    s_and_b32 s53, s46, 0xffff0000
    s_lshl_b32 s54, s47, 16
    s_and_b32 s55, s47, 0xffff0000
    s_lshl_b32 s77, s49, 4
    s_lshr_b64 s[44:45], s[44:45], s77
    s_lshl_b32 s44, s44, 16
    s_waitcnt vmcnt(5)
    ds_write_b128 v108, v[92:95]
    v_lshlrev_b32 v128, 16, v92
    v_and_b32 v129, 0xffff0000, v92
    v_lshlrev_b32 v130, 16, v93
    v_and_b32 v131, 0xffff0000, v93
    v_lshlrev_b32 v132, 16, v94
    v_and_b32 v133, 0xffff0000, v94
    v_lshlrev_b32 v134, 16, v95
    v_and_b32 v135, 0xffff0000, v95
    v_readfirstlane_b32 s78, v128
    s_nop 1
    v_pk_add_f32 v[136:137], v[128:129], s[78:79] op_sel_hi:[1,0] neg_lo:[0,1] neg_hi:[0,1]
    v_pk_add_f32 v[138:139], v[130:131], s[78:79] op_sel_hi:[1,0] neg_lo:[0,1] neg_hi:[0,1]
    v_pk_add_f32 v[140:141], v[132:133], s[78:79] op_sel_hi:[1,0] neg_lo:[0,1] neg_hi:[0,1]
    v_pk_add_f32 v[142:143], v[134:135], s[78:79] op_sel_hi:[1,0] neg_lo:[0,1] neg_hi:[0,1]
    v_pk_add_f32 v[144:145], v[136:137], v[138:139]
    v_pk_mul_f32 v[146:147], v[136:137], v[136:137]
    v_pk_add_f32 v[148:149], v[140:141], v[142:143]
    v_pk_fma_f32 v[146:147], v[138:139], v[138:139], v[146:147]
    v_pk_add_f32 v[144:145], v[144:145], v[148:149]
    v_pk_fma_f32 v[146:147], v[140:141], v[140:141], v[146:147]
    v_add_f32 v144, v144, v145
    v_pk_fma_f32 v[146:147], v[142:143], v[142:143], v[146:147]
    s_nop 0
    v_add_f32 v145, v146, v147
    v_add_f32_dpp v144, v144, v144 quad_perm:[1,0,3,2] row_mask:0xf bank_mask:0xf
    s_nop 0
    v_add_f32_dpp v145, v145, v145 quad_perm:[1,0,3,2] row_mask:0xf bank_mask:0xf
    v_add_f32_dpp v144, v144, v144 quad_perm:[2,3,0,1] row_mask:0xf bank_mask:0xf
    s_nop 0
    v_add_f32_dpp v145, v145, v145 quad_perm:[2,3,0,1] row_mask:0xf bank_mask:0xf
    v_add_f32_dpp v144, v144, v144 row_half_mirror row_mask:0xf bank_mask:0xf
    s_nop 0
    v_add_f32_dpp v145, v145, v145 row_half_mirror row_mask:0xf bank_mask:0xf
    v_add_f32_dpp v144, v144, v144 row_mirror row_mask:0xf bank_mask:0xf
    s_nop 0
    v_add_f32_dpp v145, v145, v145 row_mirror row_mask:0xf bank_mask:0xf
    v_add_f32_dpp v144, v144, v144 row_bcast:15 row_mask:0xa bank_mask:0xf
    s_nop 0
    v_add_f32_dpp v145, v145, v145 row_bcast:15 row_mask:0xa bank_mask:0xf
    v_add_f32_dpp v144, v144, v144 row_bcast:31 row_mask:0xc bank_mask:0xf
    s_nop 0
    v_add_f32_dpp v145, v145, v145 row_bcast:31 row_mask:0xc bank_mask:0xf
    v_readlane_b32 s70, v144, 63
    v_readlane_b32 s77, v145, 63
    v_mov_b32 v146, 0x3b000000
    v_mul_f32 v144, s70, v146
    v_mul_f32 v145, s77, v146
    v_add_f32 v147, s78, v144
    v_fma_f32 v145, -v144, v144, v145
    v_max_f32 v145, 0, v145
    v_cvt_pk_bf16_f32 v145, v145, v145
    v_and_b32 v145, 0xffff0000, v145
    v_add_f32 v145, 0x3727c5ac, v145
    v_cvt_pk_bf16_f32 v145, v145, v145
    v_and_b32 v145, 0xffff0000, v145
    v_sqrt_f32 v145, v145
    v_add_u32 v149, 1024, v108
    v_cvt_pk_bf16_f32 v148, v147, v145
    s_mov_b64 exec, 1
    ds_write_b32 v149, v148
    s_mov_b64 exec, -1
    s_waitcnt lgkmcnt(0)
    s_barrier
    ds_read_b64 v[152:153], v109
    ds_read_b64 v[156:157], v109 offset:512
    ds_read_b32 v160, v111
    v_lshlrev_b32 v150, 16, v148
    v_and_b32 v151, 0xffff0000, v148
    v_rcp_f32 v151, v151
    s_nop 0
    v_pk_add_f32 v[136:137], v[128:129], v[150:151] op_sel_hi:[1,0] neg_lo:[0,1] neg_hi:[0,1]
    v_pk_add_f32 v[138:139], v[130:131], v[150:151] op_sel_hi:[1,0] neg_lo:[0,1] neg_hi:[0,1]
    v_pk_add_f32 v[140:141], v[132:133], v[150:151] op_sel_hi:[1,0] neg_lo:[0,1] neg_hi:[0,1]
    v_pk_add_f32 v[142:143], v[134:135], v[150:151] op_sel_hi:[1,0] neg_lo:[0,1] neg_hi:[0,1]
    s_waitcnt lgkmcnt(0)
    v_alignbit_b32 v154, v160, v153, 16
    v_alignbit_b32 v155, s41, v160, 16
    v_mov_b32_sdwa v153, s40 dst_sel:WORD_1 dst_unused:UNUSED_PRESERVE src0_sel:WORD_0
    v_alignbit_b32 v158, v160, v157, 16
    v_alignbit_b32 v159, s41, v160, 16
    v_mov_b32_sdwa v157, s40 dst_sel:WORD_1 dst_unused:UNUSED_PRESERVE src0_sel:WORD_0
    buffer_store_dwordx4 v[152:155], v110, s[32:35], s73 offen sc1
    buffer_store_dwordx4 v[156:159], v110, s[32:35], s74 offen sc1
    v_cvt_pk_bf16_f32 v164, v136, v137
    v_cvt_pk_bf16_f32 v165, v138, v139
    v_cvt_pk_bf16_f32 v166, v140, v141
    v_cvt_pk_bf16_f32 v167, v142, v143
    v_lshlrev_b32 v136, 16, v164
    v_and_b32 v137, 0xffff0000, v164
    v_lshlrev_b32 v138, 16, v165
    v_and_b32 v139, 0xffff0000, v165
    v_lshlrev_b32 v140, 16, v166
    v_and_b32 v141, 0xffff0000, v166
    v_lshlrev_b32 v142, 16, v167
    v_and_b32 v143, 0xffff0000, v167
    v_pk_mul_f32 v[136:137], v[136:137], v[150:151] op_sel:[0,1] op_sel_hi:[1,1]
    v_pk_mul_f32 v[138:139], v[138:139], v[150:151] op_sel:[0,1] op_sel_hi:[1,1]
    v_pk_mul_f32 v[140:141], v[140:141], v[150:151] op_sel:[0,1] op_sel_hi:[1,1]
    v_pk_mul_f32 v[142:143], v[142:143], v[150:151] op_sel:[0,1] op_sel_hi:[1,1]
    v_cvt_pk_bf16_f32 v164, v136, v137
    v_cvt_pk_bf16_f32 v165, v138, v139
    v_cvt_pk_bf16_f32 v166, v140, v141
    v_cvt_pk_bf16_f32 v167, v142, v143
    s_waitcnt vmcnt(2)
    v_dot2_f32_bf16 v144, v164, v96, 0
    v_dot2_f32_bf16 v144, v165, v97, v144
    v_dot2_f32_bf16 v144, v166, v98, v144
    v_dot2_f32_bf16 v144, v167, v99, v144
    s_nop 2
    v_add_f32_dpp v144, v144, v144 quad_perm:[1,0,3,2] row_mask:0xf bank_mask:0xf
    s_nop 1
    v_add_f32_dpp v144, v144, v144 quad_perm:[2,3,0,1] row_mask:0xf bank_mask:0xf
    s_nop 1
    v_add_f32_dpp v144, v144, v144 row_half_mirror row_mask:0xf bank_mask:0xf
    s_nop 1
    v_add_f32_dpp v144, v144, v144 row_mirror row_mask:0xf bank_mask:0xf
    s_nop 1
    v_add_f32_dpp v144, v144, v144 row_bcast:15 row_mask:0xa bank_mask:0xf
    s_nop 1
    v_add_f32_dpp v144, v144, v144 row_bcast:31 row_mask:0xc bank_mask:0xf
    v_cvt_pk_bf16_f32 v144, v144, v144
    s_nop 0
    v_readlane_b32 s70, v144, 63
    s_lshl_b32 s77, s2, 3
    s_add_u32 s77, s77, s3
    s_sub_u32 s77, 2047, s77
    s_ashr_i32 s78, s70, 31
    s_or_b32 s78, s78, 0x80000000
    s_xor_b32 s70, s70, s78
    s_and_b32 s70, s70, 0xffff0000
    s_or_b32 s70, s70, s77
    v_mov_b32 v149, s70
    v_mov_b32 v146, 163584
    s_mov_b64 exec, 1
    ds_max_u64 v146, v[148:149]
    s_mov_b64 exec, -1
    s_waitcnt lgkmcnt(0)
    s_barrier
    s_cmp_eq_u32 s3, 0
    s_cbranch_scc0 recurr_nc_1
    ds_read_b64 v[152:153], v146
    s_lshl_b32 s70, s2, 4
    s_add_u32 s70, s70, 4096
    v_mov_b32 v147, 0
    s_waitcnt lgkmcnt(0)
    v_alignbit_b32 v154, s41, v152, 16
    v_mov_b32 v155, v153
    v_mov_b32_sdwa v152, s40 dst_sel:WORD_1 dst_unused:UNUSED_PRESERVE src0_sel:WORD_0
    s_mov_b64 exec, 1
    buffer_store_dwordx4 v[152:155], v147, s[32:35], s70 offen sc1
    s_mov_b64 exec, -1
recurr_nc_1:
    s_mov_b32 m0, s76
    v_mov_b32 v130, s44
    v_mul_f32 v128, 0x3fb8aa00, v130
    v_mul_f32 v129, 0x36a407db, v130
    v_exp_f32 v128, v128
    s_nop 0
    v_fma_f32 v128, v128, v129, v128
    v_cvt_pk_bf16_f32 v128, v128, v128
    v_and_b32 v128, 0xffff0000, v128
    v_mul_f32 v130, 0x3fb8aa00, v100
    v_mul_f32 v131, 0x36a407db, v100
    v_exp_f32 v130, v130
    s_nop 0
    v_fma_f32 v130, v130, v131, v130
    v_cvt_pk_bf16_f32 v130, v130, v130
    v_and_b32 v130, 0xffff0000, v130
    v_mul_f32 v130, v130, v128
    v_mul_f32 v131, v101, v128
    v_mul_f32 v130, 0xbfb8aa3b, v130
    v_mul_f32 v131, 0.15915494, v131
    v_add_f32 v128, v128, v128
    v_mul_f32 v146, v102, v128
    v_mul_f32 v147, v103, v128
    v_mul_f32 v132, 0x41000000, v130
    v_mul_f32 v133, 0x41000000, v131
    v_mul_f32 v134, 0x43000000, v130
    v_mul_f32 v135, 0x43000000, v131
    v_fract_f32 v131, v131
    v_fract_f32 v133, v133
    v_fract_f32 v135, v135
    v_exp_f32 v130, v130
    v_exp_f32 v132, v132
    v_exp_f32 v134, v134
    v_cos_f32 v140, v131
    v_sin_f32 v141, v131
    v_cos_f32 v142, v133
    v_sin_f32 v143, v133
    v_cos_f32 v144, v135
    v_sin_f32 v145, v135
    v_mov_b32 v136, 0x3f80
    ds_write_addtid_b32 v136 offset:0
    v_pk_mul_f32 v[140:141], v[140:141], v[130:131] op_sel_hi:[1,0]
    v_pk_mul_f32 v[142:143], v[142:143], v[132:133] op_sel_hi:[1,0] neg_hi:[1,0]
    v_pk_mul_f32 v[144:145], v[144:145], v[134:135] op_sel_hi:[1,0]
    global_load_short_d16_hi v36, v46, s[26:27] offset:-4096
    global_load_short_d16_hi v37, v46, s[26:27] offset:-3072
    global_load_short_d16_hi v38, v46, s[26:27] offset:-2048
    global_load_short_d16_hi v39, v46, s[26:27] offset:-1024
    global_load_short_d16_hi v40, v46, s[26:27] offset:0
    global_load_short_d16_hi v41, v46, s[26:27] offset:1024
    global_load_short_d16_hi v42, v46, s[26:27] offset:2048
    global_load_short_d16_hi v43, v46, s[26:27] offset:3072
    v_pk_mul_f32 v[248:249], v[146:147], v[144:145] op_sel:[1,1] op_sel_hi:[1,0] neg_lo:[1,0]
    v_pk_mul_f32 v[250:251], v[142:143], v[142:143] op_sel:[1,1] op_sel_hi:[1,0] neg_lo:[1,0]
    v_pk_mul_f32 v[252:253], v[140:141], v[140:141] op_sel:[1,1] op_sel_hi:[1,0] neg_lo:[1,0]
    v_pk_mul_f32 v[254:255], v[146:147], v[140:141] op_sel:[1,1] op_sel_hi:[1,0] neg_lo:[1,0]
    v_cvt_pk_bf16_f32 v240, v142, v143
    ds_write_addtid_b32 v240 offset:1056
    v_cvt_pk_bf16_f32 v241, v146, v147
    ds_write_addtid_b32 v241 offset:16896
    v_pk_fma_f32 v[148:149], v[146:147], v[144:145], v[248:249] op_sel_hi:[0,1,1]
    v_pk_fma_f32 v[150:151], v[142:143], v[142:143], v[250:251] op_sel_hi:[0,1,1]
    v_pk_fma_f32 v[152:153], v[140:141], v[140:141], v[252:253] op_sel_hi:[0,1,1]
    v_pk_fma_f32 v[154:155], v[146:147], v[140:141], v[254:255] op_sel_hi:[0,1,1]
    v_pk_mul_f32 v[248:249], v[148:149], v[144:145] op_sel:[1,1] op_sel_hi:[1,0] neg_lo:[1,0]
    v_pk_mul_f32 v[250:251], v[150:151], v[142:143] op_sel:[1,1] op_sel_hi:[1,0] neg_lo:[1,0]
    v_pk_mul_f32 v[252:253], v[152:153], v[140:141] op_sel:[1,1] op_sel_hi:[1,0] neg_lo:[1,0]
    v_pk_mul_f32 v[254:255], v[152:153], v[152:153] op_sel:[1,1] op_sel_hi:[1,0] neg_lo:[1,0]
    v_cvt_pk_bf16_f32 v242, v148, v149
    ds_write_addtid_b32 v242 offset:25344
    v_cvt_pk_bf16_f32 v243, v150, v151
    ds_write_addtid_b32 v243 offset:2112
    v_cvt_pk_bf16_f32 v244, v154, v155
    ds_write_addtid_b32 v244 offset:17952
    v_pk_fma_f32 v[156:157], v[148:149], v[144:145], v[248:249] op_sel_hi:[0,1,1]
    v_pk_fma_f32 v[158:159], v[150:151], v[142:143], v[250:251] op_sel_hi:[0,1,1]
    v_pk_fma_f32 v[160:161], v[152:153], v[140:141], v[252:253] op_sel_hi:[0,1,1]
    v_pk_fma_f32 v[162:163], v[152:153], v[152:153], v[254:255] op_sel_hi:[0,1,1]
    v_pk_mul_f32 v[248:249], v[156:157], v[144:145] op_sel:[1,1] op_sel_hi:[1,0] neg_lo:[1,0]
    v_pk_mul_f32 v[250:251], v[158:159], v[142:143] op_sel:[1,1] op_sel_hi:[1,0] neg_lo:[1,0]
    v_pk_mul_f32 v[252:253], v[162:163], v[140:141] op_sel:[1,1] op_sel_hi:[1,0] neg_lo:[1,0]
    v_pk_mul_f32 v[254:255], v[162:163], v[152:153] op_sel:[1,1] op_sel_hi:[1,0] neg_lo:[1,0]
    v_cvt_pk_bf16_f32 v245, v156, v157
    ds_write_addtid_b32 v245 offset:33792
    v_cvt_pk_bf16_f32 v246, v158, v159
    ds_write_addtid_b32 v246 offset:3168
    v_pk_fma_f32 v[150:151], v[156:157], v[144:145], v[248:249] op_sel_hi:[0,1,1]
    v_pk_fma_f32 v[154:155], v[158:159], v[142:143], v[250:251] op_sel_hi:[0,1,1]
    v_pk_fma_f32 v[164:165], v[162:163], v[140:141], v[252:253] op_sel_hi:[0,1,1]
    v_pk_fma_f32 v[166:167], v[162:163], v[152:153], v[254:255] op_sel_hi:[0,1,1]
    v_pk_mul_f32 v[248:249], v[150:151], v[144:145] op_sel:[1,1] op_sel_hi:[1,0] neg_lo:[1,0]
    v_pk_mul_f32 v[250:251], v[154:155], v[142:143] op_sel:[1,1] op_sel_hi:[1,0] neg_lo:[1,0]
    v_pk_mul_f32 v[252:253], v[162:163], v[160:161] op_sel:[1,1] op_sel_hi:[1,0] neg_lo:[1,0]
    v_pk_mul_f32 v[254:255], v[146:147], v[152:153] op_sel:[1,1] op_sel_hi:[1,0] neg_lo:[1,0]
    v_cvt_pk_bf16_f32 v247, v150, v151
    ds_write_addtid_b32 v247 offset:38016
    v_cvt_pk_bf16_f32 v240, v154, v155
    ds_write_addtid_b32 v240 offset:4224
    v_pk_fma_f32 v[158:159], v[150:151], v[144:145], v[248:249] op_sel_hi:[0,1,1]
    v_pk_fma_f32 v[168:169], v[154:155], v[142:143], v[250:251] op_sel_hi:[0,1,1]
    v_pk_fma_f32 v[170:171], v[162:163], v[160:161], v[252:253] op_sel_hi:[0,1,1]
    v_pk_fma_f32 v[172:173], v[146:147], v[152:153], v[254:255] op_sel_hi:[0,1,1]
    v_pk_mul_f32 v[248:249], v[158:159], v[144:145] op_sel:[1,1] op_sel_hi:[1,0] neg_lo:[1,0]
    v_pk_mul_f32 v[250:251], v[168:169], v[142:143] op_sel:[1,1] op_sel_hi:[1,0] neg_lo:[1,0]
    v_pk_mul_f32 v[252:253], v[146:147], v[160:161] op_sel:[1,1] op_sel_hi:[1,0] neg_lo:[1,0]
    v_pk_mul_f32 v[254:255], v[146:147], v[162:163] op_sel:[1,1] op_sel_hi:[1,0] neg_lo:[1,0]
    v_cvt_pk_bf16_f32 v241, v158, v159
    ds_write_addtid_b32 v241 offset:42240
    v_cvt_pk_bf16_f32 v242, v168, v169
    ds_write_addtid_b32 v242 offset:5280
    v_cvt_pk_bf16_f32 v243, v172, v173
    ds_write_addtid_b32 v243 offset:19008
    v_pk_fma_f32 v[154:155], v[158:159], v[144:145], v[248:249] op_sel_hi:[0,1,1]
    v_pk_fma_f32 v[174:175], v[168:169], v[142:143], v[250:251] op_sel_hi:[0,1,1]
    v_pk_fma_f32 v[176:177], v[146:147], v[160:161], v[252:253] op_sel_hi:[0,1,1]
    v_pk_fma_f32 v[178:179], v[146:147], v[162:163], v[254:255] op_sel_hi:[0,1,1]
    v_pk_mul_f32 v[248:249], v[154:155], v[144:145] op_sel:[1,1] op_sel_hi:[1,0] neg_lo:[1,0]
    v_pk_mul_f32 v[250:251], v[174:175], v[142:143] op_sel:[1,1] op_sel_hi:[1,0] neg_lo:[1,0]
    v_pk_mul_f32 v[252:253], v[146:147], v[164:165] op_sel:[1,1] op_sel_hi:[1,0] neg_lo:[1,0]
    v_pk_mul_f32 v[254:255], v[146:147], v[166:167] op_sel:[1,1] op_sel_hi:[1,0] neg_lo:[1,0]
    v_cvt_pk_bf16_f32 v244, v154, v155
    ds_write_addtid_b32 v244 offset:44352
    v_cvt_pk_bf16_f32 v245, v174, v175
    ds_write_addtid_b32 v245 offset:6336
    v_cvt_pk_bf16_f32 v246, v176, v177
    ds_write_addtid_b32 v246 offset:20064
    v_cvt_pk_bf16_f32 v247, v178, v179
    ds_write_addtid_b32 v247 offset:21120
    v_pk_fma_f32 v[168:169], v[154:155], v[144:145], v[248:249] op_sel_hi:[0,1,1]
    v_pk_fma_f32 v[172:173], v[174:175], v[142:143], v[250:251] op_sel_hi:[0,1,1]
    v_pk_fma_f32 v[180:181], v[146:147], v[164:165], v[252:253] op_sel_hi:[0,1,1]
    v_pk_fma_f32 v[182:183], v[146:147], v[166:167], v[254:255] op_sel_hi:[0,1,1]
    v_pk_mul_f32 v[248:249], v[168:169], v[144:145] op_sel:[1,1] op_sel_hi:[1,0] neg_lo:[1,0]
    v_pk_mul_f32 v[250:251], v[172:173], v[142:143] op_sel:[1,1] op_sel_hi:[1,0] neg_lo:[1,0]
    v_pk_mul_f32 v[252:253], v[146:147], v[170:171] op_sel:[1,1] op_sel_hi:[1,0] neg_lo:[1,0]
    v_pk_mul_f32 v[254:255], v[148:149], v[140:141] op_sel:[1,1] op_sel_hi:[1,0] neg_lo:[1,0]
    v_cvt_pk_bf16_f32 v240, v168, v169
    ds_write_addtid_b32 v240 offset:46464
    v_cvt_pk_bf16_f32 v241, v172, v173
    ds_write_addtid_b32 v241 offset:7392
    v_cvt_pk_bf16_f32 v242, v180, v181
    ds_write_addtid_b32 v242 offset:22176
    v_cvt_pk_bf16_f32 v243, v182, v183
    ds_write_addtid_b32 v243 offset:23232
    v_pk_fma_f32 v[174:175], v[168:169], v[144:145], v[248:249] op_sel_hi:[0,1,1]
    v_pk_fma_f32 v[178:179], v[172:173], v[142:143], v[250:251] op_sel_hi:[0,1,1]
    v_pk_fma_f32 v[176:177], v[146:147], v[170:171], v[252:253] op_sel_hi:[0,1,1]
    v_pk_fma_f32 v[184:185], v[148:149], v[140:141], v[254:255] op_sel_hi:[0,1,1]
    v_pk_mul_f32 v[248:249], v[174:175], v[144:145] op_sel:[1,1] op_sel_hi:[1,0] neg_lo:[1,0]
    v_pk_mul_f32 v[250:251], v[178:179], v[142:143] op_sel:[1,1] op_sel_hi:[1,0] neg_lo:[1,0]
    v_pk_mul_f32 v[252:253], v[148:149], v[152:153] op_sel:[1,1] op_sel_hi:[1,0] neg_lo:[1,0]
    v_pk_mul_f32 v[254:255], v[148:149], v[160:161] op_sel:[1,1] op_sel_hi:[1,0] neg_lo:[1,0]
    v_cvt_pk_bf16_f32 v244, v174, v175
    ds_write_addtid_b32 v244 offset:48576
    v_cvt_pk_bf16_f32 v245, v178, v179
    ds_write_addtid_b32 v245 offset:8448
    v_cvt_pk_bf16_f32 v246, v176, v177
    ds_write_addtid_b32 v246 offset:24288
    v_cvt_pk_bf16_f32 v247, v184, v185
    ds_write_addtid_b32 v247 offset:26400
    v_pk_fma_f32 v[172:173], v[174:175], v[144:145], v[248:249] op_sel_hi:[0,1,1]
    v_pk_fma_f32 v[182:183], v[178:179], v[142:143], v[250:251] op_sel_hi:[0,1,1]
    v_pk_fma_f32 v[180:181], v[148:149], v[152:153], v[252:253] op_sel_hi:[0,1,1]
    v_pk_fma_f32 v[186:187], v[148:149], v[160:161], v[254:255] op_sel_hi:[0,1,1]
    v_pk_mul_f32 v[248:249], v[172:173], v[144:145] op_sel:[1,1] op_sel_hi:[1,0] neg_lo:[1,0]
    v_pk_mul_f32 v[250:251], v[182:183], v[142:143] op_sel:[1,1] op_sel_hi:[1,0] neg_lo:[1,0]
    v_pk_mul_f32 v[252:253], v[148:149], v[162:163] op_sel:[1,1] op_sel_hi:[1,0] neg_lo:[1,0]
    v_pk_mul_f32 v[254:255], v[148:149], v[164:165] op_sel:[1,1] op_sel_hi:[1,0] neg_lo:[1,0]
    v_cvt_pk_bf16_f32 v240, v172, v173
    ds_write_addtid_b32 v240 offset:50688
    v_cvt_pk_bf16_f32 v241, v182, v183
    ds_write_addtid_b32 v241 offset:9504
    v_cvt_pk_bf16_f32 v242, v180, v181
    ds_write_addtid_b32 v242 offset:27456
    v_cvt_pk_bf16_f32 v243, v186, v187
    ds_write_addtid_b32 v243 offset:28512
    v_pk_fma_f32 v[178:179], v[172:173], v[144:145], v[248:249] op_sel_hi:[0,1,1]
    v_pk_fma_f32 v[184:185], v[182:183], v[142:143], v[250:251] op_sel_hi:[0,1,1]
    v_pk_fma_f32 v[176:177], v[148:149], v[162:163], v[252:253] op_sel_hi:[0,1,1]
    v_pk_fma_f32 v[188:189], v[148:149], v[164:165], v[254:255] op_sel_hi:[0,1,1]
    v_pk_mul_f32 v[248:249], v[178:179], v[144:145] op_sel:[1,1] op_sel_hi:[1,0] neg_lo:[1,0]
    v_pk_mul_f32 v[250:251], v[184:185], v[142:143] op_sel:[1,1] op_sel_hi:[1,0] neg_lo:[1,0]
    v_pk_mul_f32 v[252:253], v[148:149], v[166:167] op_sel:[1,1] op_sel_hi:[1,0] neg_lo:[1,0]
    v_pk_mul_f32 v[254:255], v[148:149], v[170:171] op_sel:[1,1] op_sel_hi:[1,0] neg_lo:[1,0]
    v_cvt_pk_bf16_f32 v244, v178, v179
    ds_write_addtid_b32 v244 offset:51744
    v_cvt_pk_bf16_f32 v245, v184, v185
    ds_write_addtid_b32 v245 offset:10560
    v_cvt_pk_bf16_f32 v246, v176, v177
    ds_write_addtid_b32 v246 offset:29568
    v_cvt_pk_bf16_f32 v247, v188, v189
    ds_write_addtid_b32 v247 offset:30624
    v_pk_fma_f32 v[182:183], v[178:179], v[144:145], v[248:249] op_sel_hi:[0,1,1]
    v_pk_fma_f32 v[172:173], v[184:185], v[142:143], v[250:251] op_sel_hi:[0,1,1]
    v_pk_fma_f32 v[186:187], v[148:149], v[166:167], v[252:253] op_sel_hi:[0,1,1]
    v_pk_fma_f32 v[180:181], v[148:149], v[170:171], v[254:255] op_sel_hi:[0,1,1]
    v_pk_mul_f32 v[248:249], v[182:183], v[144:145] op_sel:[1,1] op_sel_hi:[1,0] neg_lo:[1,0]
    v_pk_mul_f32 v[250:251], v[172:173], v[142:143] op_sel:[1,1] op_sel_hi:[1,0] neg_lo:[1,0]
    v_pk_mul_f32 v[252:253], v[156:157], v[152:153] op_sel:[1,1] op_sel_hi:[1,0] neg_lo:[1,0]
    v_pk_mul_f32 v[254:255], v[156:157], v[162:163] op_sel:[1,1] op_sel_hi:[1,0] neg_lo:[1,0]
    v_cvt_pk_bf16_f32 v240, v182, v183
    ds_write_addtid_b32 v240 offset:52800
    v_cvt_pk_bf16_f32 v241, v172, v173
    ds_write_addtid_b32 v241 offset:11616
    v_cvt_pk_bf16_f32 v242, v186, v187
    ds_write_addtid_b32 v242 offset:31680
    v_cvt_pk_bf16_f32 v243, v180, v181
    ds_write_addtid_b32 v243 offset:32736
    v_pk_fma_f32 v[184:185], v[182:183], v[144:145], v[248:249] op_sel_hi:[0,1,1]
    v_pk_fma_f32 v[178:179], v[172:173], v[142:143], v[250:251] op_sel_hi:[0,1,1]
    v_pk_fma_f32 v[188:189], v[156:157], v[152:153], v[252:253] op_sel_hi:[0,1,1]
    v_pk_fma_f32 v[176:177], v[156:157], v[162:163], v[254:255] op_sel_hi:[0,1,1]
    v_pk_mul_f32 v[248:249], v[184:185], v[144:145] op_sel:[1,1] op_sel_hi:[1,0] neg_lo:[1,0]
    v_pk_mul_f32 v[250:251], v[178:179], v[142:143] op_sel:[1,1] op_sel_hi:[1,0] neg_lo:[1,0]
    v_pk_mul_f32 v[252:253], v[156:157], v[166:167] op_sel:[1,1] op_sel_hi:[1,0] neg_lo:[1,0]
    v_pk_mul_f32 v[254:255], v[150:151], v[152:153] op_sel:[1,1] op_sel_hi:[1,0] neg_lo:[1,0]
    v_cvt_pk_bf16_f32 v244, v184, v185
    ds_write_addtid_b32 v244 offset:53856
    v_cvt_pk_bf16_f32 v245, v178, v179
    ds_write_addtid_b32 v245 offset:12672
    v_cvt_pk_bf16_f32 v246, v188, v189
    ds_write_addtid_b32 v246 offset:34848
    v_cvt_pk_bf16_f32 v247, v176, v177
    ds_write_addtid_b32 v247 offset:35904
    v_pk_fma_f32 v[172:173], v[184:185], v[144:145], v[248:249] op_sel_hi:[0,1,1]
    v_pk_fma_f32 v[182:183], v[178:179], v[142:143], v[250:251] op_sel_hi:[0,1,1]
    v_pk_fma_f32 v[180:181], v[156:157], v[166:167], v[252:253] op_sel_hi:[0,1,1]
    v_pk_fma_f32 v[186:187], v[150:151], v[152:153], v[254:255] op_sel_hi:[0,1,1]
    v_pk_mul_f32 v[248:249], v[172:173], v[144:145] op_sel:[1,1] op_sel_hi:[1,0] neg_lo:[1,0]
    v_pk_mul_f32 v[250:251], v[182:183], v[142:143] op_sel:[1,1] op_sel_hi:[1,0] neg_lo:[1,0]
    v_pk_mul_f32 v[252:253], v[150:151], v[162:163] op_sel:[1,1] op_sel_hi:[1,0] neg_lo:[1,0]
    v_pk_mul_f32 v[254:255], v[150:151], v[166:167] op_sel:[1,1] op_sel_hi:[1,0] neg_lo:[1,0]
    v_cvt_pk_bf16_f32 v240, v172, v173
    ds_write_addtid_b32 v240 offset:54912
    v_cvt_pk_bf16_f32 v241, v182, v183
    ds_write_addtid_b32 v241 offset:13728
    v_cvt_pk_bf16_f32 v242, v180, v181
    ds_write_addtid_b32 v242 offset:36960
    v_cvt_pk_bf16_f32 v243, v186, v187
    ds_write_addtid_b32 v243 offset:39072
    v_pk_fma_f32 v[178:179], v[172:173], v[144:145], v[248:249] op_sel_hi:[0,1,1]
    v_pk_fma_f32 v[184:185], v[182:183], v[142:143], v[250:251] op_sel_hi:[0,1,1]
    v_pk_fma_f32 v[176:177], v[150:151], v[162:163], v[252:253] op_sel_hi:[0,1,1]
    v_pk_fma_f32 v[188:189], v[150:151], v[166:167], v[254:255] op_sel_hi:[0,1,1]
    v_pk_mul_f32 v[248:249], v[178:179], v[144:145] op_sel:[1,1] op_sel_hi:[1,0] neg_lo:[1,0]
    v_pk_mul_f32 v[250:251], v[184:185], v[142:143] op_sel:[1,1] op_sel_hi:[1,0] neg_lo:[1,0]
    v_pk_mul_f32 v[252:253], v[158:159], v[162:163] op_sel:[1,1] op_sel_hi:[1,0] neg_lo:[1,0]
    v_pk_mul_f32 v[254:255], v[154:155], v[162:163] op_sel:[1,1] op_sel_hi:[1,0] neg_lo:[1,0]
    v_cvt_pk_bf16_f32 v244, v178, v179
    ds_write_addtid_b32 v244 offset:55968
    v_cvt_pk_bf16_f32 v245, v184, v185
    ds_write_addtid_b32 v245 offset:14784
    v_cvt_pk_bf16_f32 v246, v176, v177
    ds_write_addtid_b32 v246 offset:40128
    v_cvt_pk_bf16_f32 v247, v188, v189
    ds_write_addtid_b32 v247 offset:41184
    v_pk_fma_f32 v[182:183], v[178:179], v[144:145], v[248:249] op_sel_hi:[0,1,1]
    v_pk_fma_f32 v[172:173], v[184:185], v[142:143], v[250:251] op_sel_hi:[0,1,1]
    v_pk_fma_f32 v[186:187], v[158:159], v[162:163], v[252:253] op_sel_hi:[0,1,1]
    v_pk_fma_f32 v[180:181], v[154:155], v[162:163], v[254:255] op_sel_hi:[0,1,1]
    v_pk_mul_f32 v[248:249], v[182:183], v[144:145] op_sel:[1,1] op_sel_hi:[1,0] neg_lo:[1,0]
    v_pk_mul_f32 v[250:251], v[168:169], v[162:163] op_sel:[1,1] op_sel_hi:[1,0] neg_lo:[1,0]
    v_pk_mul_f32 v[252:253], v[174:175], v[162:163] op_sel:[1,1] op_sel_hi:[1,0] neg_lo:[1,0]
    v_cvt_pk_bf16_f32 v240, v182, v183
    ds_write_addtid_b32 v240 offset:57024
    v_cvt_pk_bf16_f32 v241, v172, v173
    ds_write_addtid_b32 v241 offset:15840
    v_cvt_pk_bf16_f32 v242, v186, v187
    ds_write_addtid_b32 v242 offset:43296
    v_cvt_pk_bf16_f32 v243, v180, v181
    ds_write_addtid_b32 v243 offset:45408
    v_pk_fma_f32 v[184:185], v[182:183], v[144:145], v[248:249] op_sel_hi:[0,1,1]
    v_pk_fma_f32 v[178:179], v[168:169], v[162:163], v[250:251] op_sel_hi:[0,1,1]
    v_pk_fma_f32 v[188:189], v[174:175], v[162:163], v[252:253] op_sel_hi:[0,1,1]
    v_pk_mul_f32 v[248:249], v[184:185], v[144:145] op_sel:[1,1] op_sel_hi:[1,0] neg_lo:[1,0]
    v_cvt_pk_bf16_f32 v244, v184, v185
    ds_write_addtid_b32 v244 offset:58080
    v_cvt_pk_bf16_f32 v245, v178, v179
    ds_write_addtid_b32 v245 offset:47520
    v_cvt_pk_bf16_f32 v246, v188, v189
    ds_write_addtid_b32 v246 offset:49632
    v_pk_fma_f32 v[182:183], v[184:185], v[144:145], v[248:249] op_sel_hi:[0,1,1]
    v_cvt_pk_bf16_f32 v247, v182, v183
    ds_write_addtid_b32 v247 offset:59136
    s_cmp_lt_u32 s3, 4
    s_cbranch_scc0 recurr_np_2
    s_mov_b32 s70, 4096
    buffer_load_dwordx4 v[64:67], v27, s[32:35], s70 offen sc1
recurr_np_2:
    buffer_load_dwordx4 v[48:51], v27, s[32:35], s56 offen sc1
    buffer_load_dwordx4 v[52:55], v27, s[32:35], s57 offen sc1
    buffer_load_dwordx4 v[56:59], v27, s[32:35], s58 offen sc1
    buffer_load_dwordx4 v[60:63], v27, s[32:35], s59 offen sc1
    s_waitcnt lgkmcnt(0)
    s_barrier
    s_cmp_eq_u32 s75, 0
    s_cbranch_scc0 recurr_kb_3
    ds_read_b128 v[128:131], v84 offset:0
    ds_read_b128 v[160:163], v84 offset:16896
    s_mul_i32 s70, s49, 4608
    s_lshl_b32 s73, s75, 8
    s_sub_u32 s70, s70, s73
    s_add_u32 s70, s70, 120672
    v_lshlrev_b32 v108, 4, v105
    v_lshl_add_u32 v108, v104, 5, v108
    v_add_u32 v21, s70, v108
    ds_read_b128 v[192:195], v85 offset:0
    s_lshl_b32 s70, s75, 2
    s_add_u32 s70, s70, s49
    s_mul_i32 s70, s70, 1280
    v_mul_u32_u24 v108, 288, v105
    v_lshl_add_u32 v108, v104, 4, v108
    v_add_u32 v22, s70, v108
    v_bfe_u32 v108, v0, 2, 2
    ds_read_b128 v[132:135], v84 offset:64
    v_mul_u32_u24 v108, 288, v108
    v_and_b32 v109, 0xf0, v0
    v_add_u32 v108, v108, v109
    v_and_b32 v109, 3, v0
    v_lshl_add_u32 v23, v109, 2, v108
    s_mul_i32 s70, s51, 10240
    v_add_u32 v23, s70, v23
    ds_read_b128 v[164:167], v84 offset:16960
    v_and_b32 v108, 255, v0
    v_lshlrev_b32 v108, 10, v108
    v_add_u32 v24, s36, v108
    s_lshl_b32 s70, s51, 10
    s_add_u32 s73, s70, 120896
    v_lshl_add_u32 v25, v0, 1, s73
    s_sub_u32 s73, 121920, s70
    ds_read_b128 v[196:199], v85 offset:64
    v_lshl_add_u32 v26, v0, 1, s73
    v_cvt_f32_i32 v112, v106
    v_subrev_f32 v113, 0x3f800000, v112
    v_subrev_f32 v114, 0x40000000, v112
    v_subrev_f32 v115, 0x40400000, v112
    v_subrev_f32 v116, 0x40800000, v112
    v_subrev_f32 v117, 0x40a00000, v112
    ds_read_b128 v[136:139], v84 offset:128
    v_subrev_f32 v118, 0x40c00000, v112
    v_subrev_f32 v119, 0x40e00000, v112
    v_mov_b32 v120, 0x4b400000
    s_mov_b32 s71, 0x05040100
    s_mov_b32 s72, 0x02020202
    s_mov_b32 s73, 0x3f000000
    v_fma_f32 v92, v116, s73, v120
    ds_read_b128 v[168:171], v84 offset:17024
    v_fma_f32 v93, v117, s73, v120
    v_fma_f32 v94, v118, s73, v120
    v_fma_f32 v95, v119, s73, v120
    v_and_b32 v121, -2, v95
    v_subrev_u32 v121, 0x4b400000, v121
    v_mul_i32_i24 v122, 0x0202, v121
    v_sub_u32 v122, 0x0100, v122
    ds_read_b128 v[200:203], v85 offset:128
    v_perm_b32 v122, v122, v122, s71
    v_bfe_u32 v123, v121, 1, 2
    s_mul_i32 s74, s75, 128
    s_add_u32 s74, s74, s68
    s_add_u32 s74, s74, 944
    v_lshl_add_u32 v121, v121, 1, s74
    v_mad_u32_u24 v18, v123, s69, v121
    ds_read_b128 v[140:143], v84 offset:192
    v_perm_b32 v7, v95, v94, s71
    v_perm_b32 v8, v93, v92, s71
    v_pk_mad_u16 v7, v7, s72, v122
    v_pk_mad_u16 v8, v8, s72, v122
    s_mov_b32 s73, 0x3e800000
    v_fma_f32 v88, v112, s73, v120
    v_fma_f32 v89, v113, s73, v120
    ds_read_b128 v[172:175], v84 offset:17088
    v_fma_f32 v90, v114, s73, v120
    v_fma_f32 v91, v115, s73, v120
    v_fma_f32 v92, v116, s73, v120
    v_fma_f32 v93, v117, s73, v120
    v_fma_f32 v94, v118, s73, v120
    v_fma_f32 v95, v119, s73, v120
    v_and_b32 v121, -2, v95
    ds_read_b128 v[204:207], v85 offset:192
    v_subrev_u32 v121, 0x4b400000, v121
    v_mul_i32_i24 v122, 0x0202, v121
    v_sub_u32 v122, 0x0100, v122
    v_perm_b32 v122, v122, v122, s71
    v_bfe_u32 v123, v121, 1, 1
    s_mul_i32 s74, s75, 64
    s_add_u32 s74, s74, s68
    ds_read_b128 v[144:147], v84 offset:256
    s_add_u32 s74, s74, 1256
    v_lshl_add_u32 v121, v121, 1, s74
    v_mad_u32_u24 v19, v123, s69, v121
    v_perm_b32 v9, v89, v88, s71
    v_perm_b32 v10, v91, v90, s71
    v_perm_b32 v11, v93, v92, s71
    v_perm_b32 v12, v95, v94, s71
    ds_read_b128 v[176:179], v84 offset:17152
    v_pk_mad_u16 v9, v9, s72, v122
    v_pk_mad_u16 v10, v10, s72, v122
    v_pk_mad_u16 v11, v11, s72, v122
    v_pk_mad_u16 v12, v12, s72, v122
    s_mov_b32 s73, 0x3e000000
    v_fma_f32 v88, v112, s73, v120
    v_fma_f32 v89, v113, s73, v120
    ds_read_b128 v[208:211], v85 offset:256
    v_fma_f32 v90, v114, s73, v120
    v_fma_f32 v91, v115, s73, v120
    v_fma_f32 v92, v116, s73, v120
    v_fma_f32 v93, v117, s73, v120
    v_fma_f32 v94, v118, s73, v120
    v_fma_f32 v95, v119, s73, v120
    v_and_b32 v121, -2, v95
    s_waitcnt lgkmcnt(12)
    v_mfma_f32_16x16x32_bf16 v[224:227], v[160:163], v[128:131], 0
    v_mfma_f32_16x16x32_bf16 v[228:231], v[128:131], v[192:195], 0
    ds_read_b128 v[148:151], v84 offset:320
    v_subrev_u32 v121, 0x4b400000, v121
    v_mul_i32_i24 v122, 0x0202, v121
    v_sub_u32 v122, 0x0100, v122
    v_perm_b32 v122, v122, v122, s71
    v_bfe_u32 v123, v121, 1, 2
    s_mul_i32 s74, s75, 32
    s_add_u32 s74, s74, s68
    ds_read_b128 v[180:183], v84 offset:17216
    s_add_u32 s74, s74, 640
    v_lshl_add_u32 v121, v121, 1, s74
    v_mad_u32_u24 v20, v123, s69, v121
    v_perm_b32 v13, v89, v88, s71
    v_perm_b32 v14, v91, v90, s71
    v_perm_b32 v15, v93, v92, s71
    v_perm_b32 v16, v95, v94, s71
    ds_read_b128 v[212:215], v85 offset:320
    v_pk_mad_u16 v13, v13, s72, v122
    v_pk_mad_u16 v14, v14, s72, v122
    v_pk_mad_u16 v15, v15, s72, v122
    v_pk_mad_u16 v16, v16, s72, v122
    v_lshrrev_b32 v108, 1, v105
    v_lshlrev_b32 v108, 8, v108
    v_lshl_add_u32 v108, v104, 4, v108
    s_waitcnt lgkmcnt(12)
    v_mfma_f32_16x16x32_bf16 v[224:227], v[164:167], v[132:135], v[224:227]
    v_mfma_f32_16x16x32_bf16 v[228:231], v[132:135], v[196:199], v[228:231]
    ds_read_b128 v[152:155], v84 offset:384
    v_and_b32 v109, 1, v105
    v_lshl_add_u32 v108, v109, 3, v108
    s_add_u32 s70, s68, 568
    v_sub_u32 v86, s70, v108
    v_lshlrev_b32 v108, 5, v104
    v_add_u32 v108, 640, v108
    v_mov_b32 v109, 1200
    ds_read_b128 v[184:187], v84 offset:17280
    v_cmp_eq_u32 vcc, 9, v104
    s_nop 1
    v_cndmask_b32 v108, v108, v109, vcc
    v_mov_b32 v109, 1512
    v_cmp_lt_u32 vcc, 9, v104
    s_nop 1
    v_cndmask_b32 v108, v108, v109, vcc
    v_lshl_add_u32 v108, v105, 3, v108
    v_add_u32 v87, s68, v108
    ds_read_b128 v[216:219], v85 offset:384
    s_waitcnt lgkmcnt(12)
    v_mfma_f32_16x16x32_bf16 v[224:227], v[168:171], v[136:139], v[224:227]
    v_mfma_f32_16x16x32_bf16 v[228:231], v[136:139], v[200:203], v[228:231]
    ds_read_b128 v[156:159], v84 offset:448
    ds_read_b128 v[188:191], v84 offset:17344
    ds_read_b128 v[220:223], v85 offset:448
    s_waitcnt lgkmcnt(12)
    v_mfma_f32_16x16x32_bf16 v[224:227], v[172:175], v[140:143], v[224:227]
    v_mfma_f32_16x16x32_bf16 v[228:231], v[140:143], v[204:207], v[228:231]
    s_waitcnt lgkmcnt(9)
    v_mfma_f32_16x16x32_bf16 v[224:227], v[176:179], v[144:147], v[224:227]
    v_mfma_f32_16x16x32_bf16 v[228:231], v[144:147], v[208:211], v[228:231]
    s_waitcnt lgkmcnt(6)
    v_mfma_f32_16x16x32_bf16 v[224:227], v[180:183], v[148:151], v[224:227]
    v_mfma_f32_16x16x32_bf16 v[228:231], v[148:151], v[212:215], v[228:231]
    s_waitcnt lgkmcnt(3)
    v_mfma_f32_16x16x32_bf16 v[224:227], v[184:187], v[152:155], v[224:227]
    v_mfma_f32_16x16x32_bf16 v[228:231], v[152:155], v[216:219], v[228:231]
    s_waitcnt lgkmcnt(0)
    v_mfma_f32_16x16x32_bf16 v[224:227], v[188:191], v[156:159], v[224:227]
    v_mfma_f32_16x16x32_bf16 v[228:231], v[156:159], v[220:223], v[228:231]
    s_nop 6
    v_cvt_pk_bf16_f32 v232, v227, v226
    v_cvt_pk_bf16_f32 v233, v225, v224
    v_cvt_pk_bf16_f32 v234, v228, v229
    v_cvt_pk_bf16_f32 v235, v230, v231
    ds_write_b64 v86, v[232:233] offset:0
    ds_write_b32 v86, v232 offset:1548
    ds_write_b32 v86, v233 offset:1552
    ds_write_b64 v86, v[232:233] offset:3096
    ds_write_b32 v86, v232 offset:4644
    ds_write_b32 v86, v233 offset:4648
    ds_write_b64 v87, v[234:235] offset:0
    ds_write_b32 v87, v234 offset:1548
    ds_write_b32 v87, v235 offset:1552
    ds_write_b64 v87, v[234:235] offset:3096
    ds_write_b32 v87, v234 offset:4644
    ds_write_b32 v87, v235 offset:4648
    s_branch recurr_kj_4
recurr_kb_3:
    ds_read_b128 v[128:131], v84 offset:0
    ds_read_b128 v[160:163], v84 offset:33792
    s_mul_i32 s70, s49, 4608
    s_lshl_b32 s73, s75, 8
    s_sub_u32 s70, s70, s73
    s_add_u32 s70, s70, 120672
    v_lshlrev_b32 v108, 4, v105
    v_lshl_add_u32 v108, v104, 5, v108
    v_add_u32 v21, s70, v108
    s_lshl_b32 s70, s75, 2
    s_add_u32 s70, s70, s49
    ds_read_b128 v[132:135], v84 offset:64
    s_mul_i32 s70, s70, 1280
    v_mul_u32_u24 v108, 288, v105
    v_lshl_add_u32 v108, v104, 4, v108
    v_add_u32 v22, s70, v108
    v_bfe_u32 v108, v0, 2, 2
    v_mul_u32_u24 v108, 288, v108
    v_and_b32 v109, 0xf0, v0
    v_add_u32 v108, v108, v109
    v_and_b32 v109, 3, v0
    ds_read_b128 v[164:167], v84 offset:33856
    v_lshl_add_u32 v23, v109, 2, v108
    s_mul_i32 s70, s51, 10240
    v_add_u32 v23, s70, v23
    v_and_b32 v108, 255, v0
    v_lshlrev_b32 v108, 10, v108
    v_add_u32 v24, s36, v108
    s_lshl_b32 s70, s51, 10
    s_add_u32 s73, s70, 120896
    v_lshl_add_u32 v25, v0, 1, s73
    ds_read_b128 v[136:139], v84 offset:128
    s_sub_u32 s73, 121920, s70
    v_lshl_add_u32 v26, v0, 1, s73
    v_cvt_f32_i32 v112, v106
    v_subrev_f32 v113, 0x3f800000, v112
    v_subrev_f32 v114, 0x40000000, v112
    v_subrev_f32 v115, 0x40400000, v112
    v_subrev_f32 v116, 0x40800000, v112
    v_subrev_f32 v117, 0x40a00000, v112
    v_subrev_f32 v118, 0x40c00000, v112
    ds_read_b128 v[168:171], v84 offset:33920
    v_subrev_f32 v119, 0x40e00000, v112
    v_mov_b32 v120, 0x4b400000
    s_mov_b32 s71, 0x05040100
    s_mov_b32 s72, 0x02020202
    s_mov_b32 s73, 0x3f000000
    v_fma_f32 v92, v116, s73, v120
    v_fma_f32 v93, v117, s73, v120
    v_fma_f32 v94, v118, s73, v120
    v_fma_f32 v95, v119, s73, v120
    ds_read_b128 v[140:143], v84 offset:192
    v_and_b32 v121, -2, v95
    v_subrev_u32 v121, 0x4b400000, v121
    v_mul_i32_i24 v122, 0x0202, v121
    v_sub_u32 v122, 0x0100, v122
    v_perm_b32 v122, v122, v122, s71
    v_bfe_u32 v123, v121, 1, 2
    s_mul_i32 s74, s75, 128
    s_add_u32 s74, s74, s68
    s_add_u32 s74, s74, 944
    ds_read_b128 v[172:175], v84 offset:33984
    v_lshl_add_u32 v121, v121, 1, s74
    v_mad_u32_u24 v18, v123, s69, v121
    v_perm_b32 v7, v95, v94, s71
    v_perm_b32 v8, v93, v92, s71
    v_pk_mad_u16 v7, v7, s72, v122
    v_pk_mad_u16 v8, v8, s72, v122
    s_mov_b32 s73, 0x3e800000
    v_fma_f32 v88, v112, s73, v120
    v_fma_f32 v89, v113, s73, v120
    ds_read_b128 v[144:147], v84 offset:256
    v_fma_f32 v90, v114, s73, v120
    v_fma_f32 v91, v115, s73, v120
    v_fma_f32 v92, v116, s73, v120
    v_fma_f32 v93, v117, s73, v120
    v_fma_f32 v94, v118, s73, v120
    v_fma_f32 v95, v119, s73, v120
    v_and_b32 v121, -2, v95
    v_subrev_u32 v121, 0x4b400000, v121
    v_mul_i32_i24 v122, 0x0202, v121
    ds_read_b128 v[176:179], v84 offset:34048
    v_sub_u32 v122, 0x0100, v122
    v_perm_b32 v122, v122, v122, s71
    v_bfe_u32 v123, v121, 1, 1
    s_mul_i32 s74, s75, 64
    s_add_u32 s74, s74, s68
    s_add_u32 s74, s74, 1256
    v_lshl_add_u32 v121, v121, 1, s74
    v_mad_u32_u24 v19, v123, s69, v121
    v_perm_b32 v9, v89, v88, s71
    ds_read_b128 v[148:151], v84 offset:320
    v_perm_b32 v10, v91, v90, s71
    v_perm_b32 v11, v93, v92, s71
    v_perm_b32 v12, v95, v94, s71
    v_pk_mad_u16 v9, v9, s72, v122
    v_pk_mad_u16 v10, v10, s72, v122
    v_pk_mad_u16 v11, v11, s72, v122
    v_pk_mad_u16 v12, v12, s72, v122
    s_mov_b32 s73, 0x3e000000
    v_fma_f32 v88, v112, s73, v120
    ds_read_b128 v[180:183], v84 offset:34112
    v_fma_f32 v89, v113, s73, v120
    v_fma_f32 v90, v114, s73, v120
    v_fma_f32 v91, v115, s73, v120
    v_fma_f32 v92, v116, s73, v120
    v_fma_f32 v93, v117, s73, v120
    v_fma_f32 v94, v118, s73, v120
    v_fma_f32 v95, v119, s73, v120
    v_and_b32 v121, -2, v95
    v_subrev_u32 v121, 0x4b400000, v121
    ds_read_b128 v[152:155], v84 offset:384
    v_mul_i32_i24 v122, 0x0202, v121
    v_sub_u32 v122, 0x0100, v122
    v_perm_b32 v122, v122, v122, s71
    v_bfe_u32 v123, v121, 1, 2
    s_mul_i32 s74, s75, 32
    s_add_u32 s74, s74, s68
    s_add_u32 s74, s74, 640
    v_lshl_add_u32 v121, v121, 1, s74
    v_mad_u32_u24 v20, v123, s69, v121
    ds_read_b128 v[184:187], v84 offset:34176
    v_perm_b32 v13, v89, v88, s71
    v_perm_b32 v14, v91, v90, s71
    v_perm_b32 v15, v93, v92, s71
    v_perm_b32 v16, v95, v94, s71
    v_pk_mad_u16 v13, v13, s72, v122
    v_pk_mad_u16 v14, v14, s72, v122
    v_pk_mad_u16 v15, v15, s72, v122
    v_pk_mad_u16 v16, v16, s72, v122
    v_and_b32 v108, 1, v105
    s_waitcnt lgkmcnt(12)
    v_mfma_f32_16x16x32_bf16 v[224:227], v[160:163], v[128:131], 0
    ds_read_b128 v[156:159], v84 offset:448
    v_lshlrev_b32 v108, 7, v108
    v_add_u32 v108, s68, v108
    v_lshlrev_b32 v109, 3, v104
    v_add_u32 v109, 944, v109
    v_lshlrev_b32 v110, 2, v104
    v_add_u32 v110, 1256, v110
    v_cmp_lt_u32 vcc, 1, v105
    s_nop 1
    v_cndmask_b32 v109, v109, v110, vcc
    v_add_u32 v86, v108, v109
    ds_read_b128 v[188:191], v84 offset:34240
    v_cndmask_b32 v110, 4, 64, vcc
    v_add_u32 v87, v86, v110
    s_waitcnt lgkmcnt(12)
    v_mfma_f32_16x16x32_bf16 v[224:227], v[164:167], v[132:135], v[224:227]
    s_waitcnt lgkmcnt(10)
    v_mfma_f32_16x16x32_bf16 v[224:227], v[168:171], v[136:139], v[224:227]
    s_waitcnt lgkmcnt(8)
    v_mfma_f32_16x16x32_bf16 v[224:227], v[172:175], v[140:143], v[224:227]
    s_waitcnt lgkmcnt(6)
    v_mfma_f32_16x16x32_bf16 v[224:227], v[176:179], v[144:147], v[224:227]
    s_waitcnt lgkmcnt(4)
    v_mfma_f32_16x16x32_bf16 v[224:227], v[180:183], v[148:151], v[224:227]
    s_waitcnt lgkmcnt(2)
    v_mfma_f32_16x16x32_bf16 v[224:227], v[184:187], v[152:155], v[224:227]
    s_waitcnt lgkmcnt(0)
    v_mfma_f32_16x16x32_bf16 v[224:227], v[188:191], v[156:159], v[224:227]
    s_nop 7
    v_cvt_pk_bf16_f32 v232, v224, v225
    v_cvt_pk_bf16_f32 v233, v226, v227
    ds_write_b32 v86, v232 offset:0
    ds_write_b32 v87, v233 offset:0
    ds_write_b32 v86, v232 offset:1548
    ds_write_b32 v87, v233 offset:1548
    ds_write_b32 v86, v232 offset:3096
    ds_write_b32 v87, v233 offset:3096
    ds_write_b32 v86, v232 offset:4644
    ds_write_b32 v87, v233 offset:4644
recurr_kj_4:
    global_load_dwordx4 v[28:31], v45, s[22:23]
    global_load_dwordx4 v[32:35], v45, s[24:25]
    s_cmp_lt_u32 s3, 4
    s_cbranch_scc0 recurr_cs_5
    s_mov_b32 s71, 200000
    s_mov_b32 s70, 4096
    s_waitcnt vmcnt(6)
recurr_cr_6:
    v_cmp_eq_u32_sdwa vcc, v64, s40 src0_sel:WORD_1 src1_sel:DWORD
    v_cmp_eq_u32_sdwa s[72:73], v66, s41 src0_sel:WORD_1 src1_sel:DWORD
    s_and_b64 vcc, vcc, s[72:73]
    s_cmp_eq_u64 vcc, -1
    s_cbranch_scc1 recurr_co_7
    s_sub_u32 s71, s71, 1
    s_cbranch_scc1 recurr_co_7
    buffer_load_dwordx4 v[64:67], v27, s[32:35], s70 offen sc1
    s_waitcnt vmcnt(0)
    s_branch recurr_cr_6
recurr_co_7:
    s_mov_b32 s72, 0x05040100
    v_mov_b32 v122, v65
    v_perm_b32 v64, v66, v64, s72
    s_nop 0
    v_max_u32_dpp v122, v122, v122 quad_perm:[1,0,3,2] row_mask:0xf bank_mask:0xf
    s_nop 1
    v_max_u32_dpp v122, v122, v122 quad_perm:[2,3,0,1] row_mask:0xf bank_mask:0xf
    s_nop 1
    v_max_u32_dpp v122, v122, v122 row_half_mirror row_mask:0xf bank_mask:0xf
    s_nop 1
    v_max_u32_dpp v122, v122, v122 row_mirror row_mask:0xf bank_mask:0xf
    s_nop 1
    v_max_u32_dpp v122, v122, v122 row_bcast:15 row_mask:0xa bank_mask:0xf
    s_nop 1
    v_max_u32_dpp v122, v122, v122 row_bcast:31 row_mask:0xc bank_mask:0xf
    s_nop 0
    v_readlane_b32 s72, v122, 63
    v_mov_b32 v123, 163600
    s_nop 0
    v_cmp_eq_u32 vcc, s72, v65
    s_mov_b64 exec, vcc
    ds_max_u64 v123, v[64:65]
    s_mov_b64 exec, -1
recurr_cs_5:
    v_mov_b32 v123, 163600
    s_mov_b32 s71, 200000
    s_waitcnt vmcnt(2)
recurr_xr_8:
    v_cmp_eq_u32_sdwa vcc, v49, s40 src0_sel:WORD_1 src1_sel:DWORD
    v_cmp_eq_u32_sdwa s[68:69], v51, s41 src0_sel:WORD_1 src1_sel:DWORD
    s_and_b64 vcc, vcc, s[68:69]
    v_cmp_eq_u32_sdwa s[66:67], v53, s40 src0_sel:WORD_1 src1_sel:DWORD
    v_cmp_eq_u32_sdwa s[68:69], v55, s41 src0_sel:WORD_1 src1_sel:DWORD
    s_and_b64 vcc, vcc, s[66:67]
    s_and_b64 vcc, vcc, s[68:69]
    v_cmp_eq_u32_sdwa s[64:65], v57, s40 src0_sel:WORD_1 src1_sel:DWORD
    v_cmp_eq_u32_sdwa s[68:69], v59, s41 src0_sel:WORD_1 src1_sel:DWORD
    s_and_b64 vcc, vcc, s[64:65]
    s_and_b64 vcc, vcc, s[68:69]
    v_cmp_eq_u32_sdwa s[66:67], v61, s40 src0_sel:WORD_1 src1_sel:DWORD
    v_cmp_eq_u32_sdwa s[68:69], v63, s41 src0_sel:WORD_1 src1_sel:DWORD
    s_and_b64 vcc, vcc, s[66:67]
    s_and_b64 vcc, vcc, s[68:69]
    s_cmp_eq_u64 vcc, -1
    s_cbranch_scc1 recurr_xo_9
    s_sub_u32 s71, s71, 1
    s_cbranch_scc1 recurr_xo_9
    buffer_load_dwordx4 v[48:51], v27, s[32:35], s56 offen sc1
    buffer_load_dwordx4 v[52:55], v27, s[32:35], s57 offen sc1
    buffer_load_dwordx4 v[56:59], v27, s[32:35], s58 offen sc1
    buffer_load_dwordx4 v[60:63], v27, s[32:35], s59 offen sc1
    s_waitcnt vmcnt(0)
    s_branch recurr_xr_8
recurr_xo_9:
    v_lshlrev_b32 v117, 16, v51
    v_and_b32 v116, 0xffff0000, v50
    v_rcp_f32 v117, v117
    v_lshlrev_b32 v100, 16, v48
    v_and_b32 v101, 0xffff0000, v48
    v_lshlrev_b32 v102, 16, v49
    v_lshlrev_b32 v103, 16, v50
    v_pk_add_f32 v[104:105], v[100:101], v[116:117] op_sel_hi:[1,0] neg_lo:[0,1] neg_hi:[0,1]
    v_pk_add_f32 v[106:107], v[102:103], v[116:117] op_sel_hi:[1,0] neg_lo:[0,1] neg_hi:[0,1]
    v_cvt_pk_bf16_f32 v118, v104, v105
    v_cvt_pk_bf16_f32 v119, v106, v107
    v_lshlrev_b32 v104, 16, v118
    v_and_b32 v105, 0xffff0000, v118
    v_lshlrev_b32 v106, 16, v119
    v_and_b32 v107, 0xffff0000, v119
    v_pk_mul_f32 v[104:105], v[104:105], v[116:117] op_sel:[0,1] op_sel_hi:[1,1]
    v_pk_mul_f32 v[106:107], v[106:107], v[116:117] op_sel:[0,1] op_sel_hi:[1,1]
    v_cvt_pk_bf16_f32 v118, v104, v105
    v_cvt_pk_bf16_f32 v119, v106, v107
    v_lshlrev_b32 v104, 16, v118
    v_and_b32 v105, 0xffff0000, v118
    v_lshlrev_b32 v106, 16, v119
    v_and_b32 v107, 0xffff0000, v119
    ds_write_b16 v25, v118 offset:0
    ds_write_b16_d16_hi v25, v118 offset:4608
    ds_write_b16 v25, v119 offset:9216
    ds_write_b16_d16_hi v25, v119 offset:13824
    v_lshlrev_b32 v197, 16, v55
    v_and_b32 v196, 0xffff0000, v54
    v_rcp_f32 v197, v197
    v_lshlrev_b32 v188, 16, v52
    v_and_b32 v189, 0xffff0000, v52
    v_lshlrev_b32 v190, 16, v53
    v_lshlrev_b32 v191, 16, v54
    v_pk_add_f32 v[192:193], v[188:189], v[196:197] op_sel_hi:[1,0] neg_lo:[0,1] neg_hi:[0,1]
    v_pk_add_f32 v[194:195], v[190:191], v[196:197] op_sel_hi:[1,0] neg_lo:[0,1] neg_hi:[0,1]
    v_cvt_pk_bf16_f32 v198, v192, v193
    v_cvt_pk_bf16_f32 v199, v194, v195
    v_lshlrev_b32 v192, 16, v198
    v_and_b32 v193, 0xffff0000, v198
    v_lshlrev_b32 v194, 16, v199
    v_and_b32 v195, 0xffff0000, v199
    v_pk_mul_f32 v[192:193], v[192:193], v[196:197] op_sel:[0,1] op_sel_hi:[1,1]
    v_pk_mul_f32 v[194:195], v[194:195], v[196:197] op_sel:[0,1] op_sel_hi:[1,1]
    v_cvt_pk_bf16_f32 v198, v192, v193
    v_cvt_pk_bf16_f32 v199, v194, v195
    ds_write_b16 v26, v198 offset:0
    ds_write_b16_d16_hi v26, v198 offset:4608
    ds_write_b16 v26, v199 offset:9216
    ds_write_b16_d16_hi v26, v199 offset:13824
    v_lshlrev_b32 v117, 16, v59
    v_and_b32 v116, 0xffff0000, v58
    v_rcp_f32 v117, v117
    v_lshlrev_b32 v108, 16, v56
    v_and_b32 v109, 0xffff0000, v56
    v_lshlrev_b32 v110, 16, v57
    v_lshlrev_b32 v111, 16, v58
    v_pk_add_f32 v[112:113], v[108:109], v[116:117] op_sel_hi:[1,0] neg_lo:[0,1] neg_hi:[0,1]
    v_pk_add_f32 v[114:115], v[110:111], v[116:117] op_sel_hi:[1,0] neg_lo:[0,1] neg_hi:[0,1]
    v_cvt_pk_bf16_f32 v118, v112, v113
    v_cvt_pk_bf16_f32 v119, v114, v115
    v_lshlrev_b32 v112, 16, v118
    v_and_b32 v113, 0xffff0000, v118
    v_lshlrev_b32 v114, 16, v119
    v_and_b32 v115, 0xffff0000, v119
    v_pk_mul_f32 v[112:113], v[112:113], v[116:117] op_sel:[0,1] op_sel_hi:[1,1]
    v_pk_mul_f32 v[114:115], v[114:115], v[116:117] op_sel:[0,1] op_sel_hi:[1,1]
    v_cvt_pk_bf16_f32 v118, v112, v113
    v_cvt_pk_bf16_f32 v119, v114, v115
    v_lshlrev_b32 v112, 16, v118
    v_and_b32 v113, 0xffff0000, v118
    v_lshlrev_b32 v114, 16, v119
    v_and_b32 v115, 0xffff0000, v119
    s_waitcnt lgkmcnt(0)
    s_barrier
    ds_read_b64 v[120:121], v123
    ds_read_b128 v[128:131], v17 offset:512
    ds_read_b32 v160, v17 offset:528
    ds_read_b128 v[132:135], v17 offset:448
    ds_read_b32 v161, v17 offset:464
    ds_read_b128 v[136:139], v17 offset:384
    ds_read_b32 v162, v17 offset:400
    ds_read_b128 v[140:143], v17 offset:320
    ds_read_b32 v163, v17 offset:336
    ds_read_b128 v[180:183], v17 offset:0
    ds_read_b32 v184, v17 offset:16
    ds_write_b16 v25, v118 offset:2048
    ds_write_b16_d16_hi v25, v118 offset:6656
    ds_write_b16 v25, v119 offset:11264
    ds_write_b16_d16_hi v25, v119 offset:15872
    s_waitcnt lgkmcnt(14)
    v_readfirstlane_b32 s62, v121
    v_readfirstlane_b32 s61, v120
    s_and_b32 s60, s62, 0x7ff
    s_sub_u32 s60, 2047, s60
    s_lshl_b32 s70, s60, 10
    v_lshl_add_u32 v124, v0, 1, s70
    global_load_short_d16_hi v44, v124, s[4:5]
    s_lshr_b32 s63, s60, 8
    s_add_u32 s60, s70, s36
    s_lshr_b32 s64, s63, 1
    s_xor_b32 s64, s64, s63
    s_and_b32 s64, s64, 1
    s_mul_i32 s64, s64, 12
    s_lshl_b32 s65, s38, 3
    s_or_b32 s65, s65, s3
    s_cmp_eq_u32 s64, s65
    s_cselect_b32 s77, 1, 0
    s_mov_b32 s72, 0xbfb8aa3b
    s_or_b32 s70, s2, s3
    s_cmp_eq_u32 s70, 0
    s_cbranch_scc0 recurr_ne_10
    s_lshl_b32 s70, s40, 16
    v_mov_b32 v122, s70
    v_mov_b32 v123, 0
    s_mov_b64 exec, 1
    buffer_store_dword v122, v123, s[32:35], 0 offen sc1
    s_mov_b64 exec, -1
recurr_ne_10:
    v_lshlrev_b32 v197, 16, v63
    v_and_b32 v196, 0xffff0000, v62
    v_rcp_f32 v197, v197
    v_lshlrev_b32 v188, 16, v60
    v_and_b32 v189, 0xffff0000, v60
    v_lshlrev_b32 v190, 16, v61
    v_lshlrev_b32 v191, 16, v62
    v_pk_add_f32 v[192:193], v[188:189], v[196:197] op_sel_hi:[1,0] neg_lo:[0,1] neg_hi:[0,1]
    ds_read_b128 v[220:223], v21 offset:192
    v_pk_add_f32 v[194:195], v[190:191], v[196:197] op_sel_hi:[1,0] neg_lo:[0,1] neg_hi:[0,1]
    v_cvt_pk_bf16_f32 v198, v192, v193
    v_cvt_pk_bf16_f32 v199, v194, v195
    v_lshlrev_b32 v192, 16, v198
    v_and_b32 v193, 0xffff0000, v198
    v_lshlrev_b32 v194, 16, v199
    v_and_b32 v195, 0xffff0000, v199
    v_pk_mul_f32 v[192:193], v[192:193], v[196:197] op_sel:[0,1] op_sel_hi:[1,1]
    v_pk_mul_f32 v[194:195], v[194:195], v[196:197] op_sel:[0,1] op_sel_hi:[1,1]
    v_cvt_pk_bf16_f32 v198, v192, v193
    v_cvt_pk_bf16_f32 v199, v194, v195
    s_waitcnt lgkmcnt(11)
    ds_read_b128 v[164:167], v18 offset:0
    ds_read_b128 v[168:171], v18 offset:32
    ds_read_b128 v[172:175], v18 offset:64
    ds_read_b128 v[176:179], v18 offset:96
    v_pk_mul_f32 v[68:69], v[104:105], s[72:73] op_sel_hi:[1,0]
    v_pk_mul_f32 v[70:71], v[106:107], s[72:73] op_sel_hi:[1,0]
    v_exp_f32 v68, v68
    v_exp_f32 v69, v69
    v_exp_f32 v70, v70
    v_exp_f32 v71, v71
    v_pk_add_f32 v[68:69], v[68:69], 1.0 op_sel_hi:[1,0]
    v_pk_add_f32 v[70:71], v[70:71], 1.0 op_sel_hi:[1,0]
    v_rcp_f32 v68, v68
    v_rcp_f32 v69, v69
    v_rcp_f32 v70, v70
    v_rcp_f32 v71, v71
    v_pk_mul_f32 v[68:69], v[68:69], v[104:105]
    v_pk_mul_f32 v[70:71], v[70:71], v[106:107]
    v_pk_mul_f32 v[104:105], v[104:105], s[52:53]
    v_pk_mul_f32 v[106:107], v[106:107], s[54:55]
    v_pk_fma_f32 v[72:73], v[104:105], v[68:69], v[100:101]
    v_pk_fma_f32 v[74:75], v[106:107], v[70:71], v[102:103]
    s_waitcnt lgkmcnt(9)
    ds_write_b16 v26, v198 offset:2048
    ds_write_b16_d16_hi v26, v198 offset:6656
    ds_write_b16 v26, v199 offset:11264
    ds_write_b16_d16_hi v26, v199 offset:15872
v_alignbyte_b32 v128, v129, v128, v6
v_alignbyte_b32 v129, v130, v129, v6
v_alignbyte_b32 v130, v131, v130, v6
    ds_read_b128 v[224:227], v21 offset:128
v_alignbyte_b32 v131, v160, v131, v6
v_alignbyte_b32 v132, v133, v132, v6
v_alignbyte_b32 v133, v134, v133, v6
v_alignbyte_b32 v134, v135, v134, v6
v_alignbyte_b32 v135, v161, v135, v6
v_alignbyte_b32 v136, v137, v136, v6
v_alignbyte_b32 v137, v138, v137, v6
v_alignbyte_b32 v138, v139, v138, v6
    ds_read_b128 v[228:231], v21 offset:64
v_alignbyte_b32 v139, v162, v139, v6
v_alignbyte_b32 v140, v141, v140, v6
v_alignbyte_b32 v141, v142, v141, v6
v_alignbyte_b32 v142, v143, v142, v6
v_alignbyte_b32 v143, v163, v143, v6
    s_cmp_eq_u32 s75, 0
    s_cbranch_scc0 recurr_nf_11
    v_bfi_b32 v128, v2, 0, v128
    v_bfi_b32 v129, v3, 0, v129
    v_bfi_b32 v130, v4, 0, v130
    v_bfi_b32 v131, v5, 0, v131
    v_alignbyte_b32 v180, v181, v180, v6
    v_alignbyte_b32 v181, v182, v181, v6
    v_alignbyte_b32 v182, v183, v182, v6
    v_alignbyte_b32 v183, v184, v183, v6
recurr_nf_11:
    v_pk_mul_f32 v[76:77], v[112:113], s[72:73] op_sel_hi:[1,0]
    v_pk_mul_f32 v[78:79], v[114:115], s[72:73] op_sel_hi:[1,0]
    v_exp_f32 v76, v76
    v_exp_f32 v77, v77
    v_exp_f32 v78, v78
    v_exp_f32 v79, v79
    v_pk_add_f32 v[76:77], v[76:77], 1.0 op_sel_hi:[1,0]
    v_pk_add_f32 v[78:79], v[78:79], 1.0 op_sel_hi:[1,0]
    v_rcp_f32 v76, v76
    v_rcp_f32 v77, v77
    v_rcp_f32 v78, v78
    v_rcp_f32 v79, v79
    v_pk_mul_f32 v[76:77], v[76:77], v[112:113]
    v_pk_mul_f32 v[78:79], v[78:79], v[114:115]
    v_pk_mul_f32 v[112:113], v[112:113], s[52:53]
    v_pk_mul_f32 v[114:115], v[114:115], s[54:55]
    v_pk_fma_f32 v[80:81], v[112:113], v[76:77], v[108:109]
    v_pk_fma_f32 v[82:83], v[114:115], v[78:79], v[110:111]
    s_waitcnt lgkmcnt(6)
v_perm_b32 v147, v165, v164, v7
    ds_read_b128 v[232:235], v21 offset:0
v_perm_b32 v146, v165, v164, v8
v_perm_b32 v145, v166, v165, v7
v_perm_b32 v144, v166, v165, v8
v_perm_b32 v151, v169, v168, v7
v_perm_b32 v150, v169, v168, v8
v_perm_b32 v149, v170, v169, v7
v_perm_b32 v148, v170, v169, v8
v_perm_b32 v155, v173, v172, v7
    ds_read_b128 v[236:239], v21 offset:1216
v_perm_b32 v154, v173, v172, v8
v_perm_b32 v153, v174, v173, v7
v_perm_b32 v152, v174, v173, v8
v_perm_b32 v159, v177, v176, v7
v_perm_b32 v158, v177, v176, v8
v_perm_b32 v157, v178, v177, v7
v_perm_b32 v156, v178, v177, v8
    s_cmp_eq_u32 s75, 0
    s_cbranch_scc0 recurr_nf_12
    v_bfi_b32 v144, v2, v180, v144
    v_bfi_b32 v145, v3, v181, v145
    v_bfi_b32 v146, v4, v182, v146
    v_bfi_b32 v147, v5, v183, v147
recurr_nf_12:
    ds_read_b128 v[240:243], v21 offset:1152
    ds_read_b128 v[244:247], v21 offset:1088
    s_cmp_eq_u32 s43, 0
    s_cbranch_scc1 recurr_f1_13
    s_and_b32 s64, s61, 0xffff0000
    s_lshl_b32 s65, s61, 16
    v_rcp_f32 v216, s64
    v_bfe_u32 v218, v0, 5, 4
    v_mul_u32_u24 v218, 1056, v218
    v_and_b32 v219, 28, v0
    v_add3_u32 v218, v218, v219, 64
    s_waitcnt vmcnt(0)
    v_subrev_f32 v44, s65, v44
    v_cvt_pk_bf16_f32 v44, v44, v44
    v_and_b32 v44, 0xffff0000, v44
    v_mul_f32 v44, v44, v216
    v_cvt_pk_bf16_f32 v216, v44, 0
    v_lshlrev_b32 v217, 16, v216
    v_dot2_f32_bf16 v200, v28, v216, 0
    v_dot2_f32_bf16 v208, v32, v216, 0
    v_dot2_f32_bf16 v201, v28, v217, 0
    v_dot2_f32_bf16 v209, v32, v217, 0
    v_dot2_f32_bf16 v202, v29, v216, 0
    v_dot2_f32_bf16 v210, v33, v216, 0
    v_dot2_f32_bf16 v203, v29, v217, 0
    v_dot2_f32_bf16 v211, v33, v217, 0
    v_dot2_f32_bf16 v204, v30, v216, 0
    v_dot2_f32_bf16 v212, v34, v216, 0
    v_dot2_f32_bf16 v205, v30, v217, 0
    v_dot2_f32_bf16 v213, v34, v217, 0
    v_dot2_f32_bf16 v206, v31, v216, 0
    v_dot2_f32_bf16 v214, v35, v216, 0
    v_dot2_f32_bf16 v207, v31, v217, 0
    v_dot2_f32_bf16 v215, v35, v217, 0
    v_permlane32_swap_b32 v200, v208
    v_permlane32_swap_b32 v201, v209
    v_permlane32_swap_b32 v202, v210
    v_permlane32_swap_b32 v203, v211
    v_permlane32_swap_b32 v204, v212
    v_permlane32_swap_b32 v205, v213
    v_permlane32_swap_b32 v206, v214
    v_permlane32_swap_b32 v207, v215
    v_add_f32 v200, v200, v208
    v_add_f32 v201, v201, v209
    v_add_f32 v202, v202, v210
    v_add_f32 v203, v203, v211
    v_add_f32 v204, v204, v212
    v_add_f32 v205, v205, v213
    v_add_f32 v206, v206, v214
    v_add_f32 v207, v207, v215
    v_permlane16_swap_b32 v200, v204
    v_permlane16_swap_b32 v201, v205
    v_permlane16_swap_b32 v202, v206
    v_permlane16_swap_b32 v203, v207
    v_add_f32 v200, v200, v204
    v_add_f32 v201, v201, v205
    v_add_f32 v202, v202, v206
    v_add_f32 v203, v203, v207
    v_add_f32_dpp v200, v200, v200 row_ror:8 row_mask:0xf bank_mask:0x3
    v_add_f32_dpp v201, v201, v201 row_ror:8 row_mask:0xf bank_mask:0x3
    s_nop 0
    v_add_f32_dpp v200, v202, v202 row_ror:8 row_mask:0xf bank_mask:0xc
    v_add_f32_dpp v201, v203, v203 row_ror:8 row_mask:0xf bank_mask:0xc
    s_nop 0
    v_add_f32_dpp v202, v200, v200 row_half_mirror row_mask:0xf bank_mask:0x5
    s_nop 1
    v_add_f32_dpp v202, v201, v201 row_half_mirror row_mask:0xf bank_mask:0xa
    s_nop 1
    v_add_f32_dpp v202, v202, v202 quad_perm:[1,0,3,2] row_mask:0xf bank_mask:0xf
    s_nop 1
    v_add_f32_dpp v202, v202, v202 quad_perm:[2,3,0,1] row_mask:0xf bank_mask:0xf
    ds_write_b32 v218, v202 offset:26304
recurr_f1_13:
    ds_read_b128 v[248:251], v21 offset:1024
    s_waitcnt vmcnt(0)
    v_bfe_u32 v30, v0, 3, 3
    v_mul_u32_u24 v30, 1056, v30
    v_and_b32 v31, 7, v0
    v_lshl_add_u32 v30, v31, 2, v30
    v_lshrrev_b32 v32, 2, v0
    v_mul_u32_u24 v32, 5504, v32
    v_and_b32 v31, 3, v0
    v_lshl_add_u32 v32, v31, 3, v32
    v_mov_b32 v35, s42
    s_waitcnt lgkmcnt(0)
    s_barrier
    s_cmp_eq_u32 s38, 0
    s_cbranch_scc0 recurr_h1_14
    ds_read_b32 v28, v30 offset:26368
    ds_read_b32 v29, v30 offset:34816
    ds_read2_b64 v[52:55], v19 offset0:0 offset1:2
    ds_read_b128 v[60:63], v21 offset:1728
    ds_read_b128 v[64:67], v18 offset:256
    ds_read_b128 v[100:103], v21 offset:1664
    v_mfma_f32_16x16x32_bf16 v[84:87], v[128:131], v[220:223], 0
    ds_read_b128 v[104:107], v21 offset:1600
    s_waitcnt lgkmcnt(3)
    v_mfma_f32_16x16x32_bf16 v[88:91], v[128:131], v[60:63], 0
    ds_read2_b64 v[108:111], v19 offset0:4 offset1:6
    ds_read_b128 v[112:115], v21 offset:1536
    v_perm_b32 v116, v53, v52, v9
    v_perm_b32 v117, v53, v52, v10
    v_perm_b32 v118, v53, v52, v11
    v_mfma_f32_16x16x32_bf16 v[84:87], v[132:135], v[224:227], v[84:87]
    v_perm_b32 v119, v53, v52, v12
    v_add_f32 v28, v28, v29
    s_waitcnt lgkmcnt(4)
    s_cmp_eq_u32 s75, 0
    s_cbranch_scc0 recurr_nf_17
    v_perm_b32 v163, v65, v64, v7
    v_perm_b32 v162, v65, v64, v8
    v_perm_b32 v161, v66, v65, v7
    v_perm_b32 v160, v66, v65, v8
    v_bfi_b32 v116, v2, v160, v116
    v_bfi_b32 v117, v3, v161, v117
    v_bfi_b32 v118, v4, v162, v118
    v_bfi_b32 v119, v5, v163, v119
recurr_nf_17:
    s_waitcnt lgkmcnt(3)
    v_mfma_f32_16x16x32_bf16 v[88:91], v[132:135], v[100:103], v[88:91]
    v_mfma_f32_16x16x32_bf16 v[84:87], v[136:139], v[228:231], v[84:87]
    v_mov_b32 v29, v28
    v_perm_b32 v64, v55, v54, v9
    s_nop 0
    v_permlane32_swap_b32 v28, v29
    s_waitcnt lgkmcnt(0)
    v_mfma_f32_16x16x32_bf16 v[88:91], v[136:139], v[104:107], v[88:91]
    v_perm_b32 v65, v55, v54, v10
    v_add_f32 v28, v28, v29
    v_perm_b32 v66, v55, v54, v11
    v_mfma_f32_16x16x32_bf16 v[84:87], v[140:143], v[232:235], v[84:87]
    ds_read2_b64 v[160:163], v19 offset0:16 offset1:18
    ds_read_b128 v[164:167], v21 offset:704
    v_mov_b32 v29, v28
    v_perm_b32 v67, v55, v54, v12
    s_nop 0
    v_permlane16_swap_b32 v28, v29
    v_mfma_f32_16x16x32_bf16 v[88:91], v[140:143], v[112:115], v[88:91]
    ds_read_b128 v[168:171], v21 offset:640
    v_perm_b32 v172, v109, v108, v9
    v_add_f32 v28, v28, v29
    v_perm_b32 v173, v109, v108, v10
    ds_write_b128 v22, v[84:87] offset:0
    v_mfma_f32_16x16x32_bf16 v[88:91], v[144:147], v[236:239], v[88:91]
    ds_read_b128 v[52:55], v21 offset:576
    v_cvt_pk_bf16_f32 v28, v28, v28
    v_perm_b32 v174, v109, v108, v11
    v_and_b32 v28, 0xffff0000, v28
    v_mfma_f32_16x16x32_bf16 v[88:91], v[148:151], v[240:243], v[88:91]
    ds_read_b128 v[176:179], v21 offset:512
    v_perm_b32 v175, v109, v108, v12
    v_mul_f32 v29, s72, v28
    v_perm_b32 v180, v111, v110, v9
    v_mfma_f32_16x16x32_bf16 v[88:91], v[152:155], v[244:247], v[88:91]
    v_exp_f32 v29, v29
    v_perm_b32 v181, v111, v110, v10
    v_add_f32 v29, 1.0, v29
    v_mfma_f32_16x16x32_bf16 v[88:91], v[156:159], v[248:251], v[88:91]
    ds_read2_b64 v[184:187], v19 offset0:20 offset1:22
    ds_read_b128 v[188:191], v21 offset:2240
    v_perm_b32 v182, v111, v110, v11
    v_rcp_f32 v29, v29
    v_perm_b32 v183, v111, v110, v12
    s_waitcnt lgkmcnt(3)
    v_mfma_f32_16x16x32_bf16 v[88:91], v[116:119], v[164:167], v[88:91]
    v_mul_f32 v29, v29, v28
    v_perm_b32 v192, v161, v160, v9
    v_cvt_pk_bf16_f32 v29, v29, v29
    v_mfma_f32_16x16x32_bf16 v[88:91], v[64:67], v[168:171], v[88:91]
    ds_read_b128 v[108:111], v21 offset:2176
    v_perm_b32 v193, v161, v160, v10
    v_and_b32 v29, 0xffff0000, v29
    v_perm_b32 v194, v161, v160, v11
    v_mfma_f32_16x16x32_bf16 v[88:91], v[172:175], v[52:55], v[88:91]
    v_mul_f32_dpp v29, v28, v29 row_ror:8 row_mask:0xf bank_mask:0xf
    v_perm_b32 v195, v161, v160, v12
    v_cvt_pk_bf16_f32 v29, v29, v29
    s_waitcnt lgkmcnt(1)
    v_mfma_f32_16x16x32_bf16 v[88:91], v[180:183], v[176:179], v[88:91]
    ds_read_b128 v[196:199], v21 offset:2112
    v_perm_b32 v200, v163, v162, v9
    v_and_b32 v29, 0xffff0000, v29
    v_perm_b32 v201, v163, v162, v10
    v_mfma_f32_16x16x32_bf16 v[88:91], v[192:195], v[220:223], v[88:91]
    ds_read_b128 v[204:207], v20 offset:0
    ds_read_b128 v[208:211], v21 offset:2048
    v_readlane_b32 s65, v29, 0
    v_readlane_b32 s66, v29, 1
    v_readlane_b32 s67, v29, 2
    v_readlane_b32 s68, v29, 3
    v_readlane_b32 s69, v29, 4
    v_readlane_b32 s70, v29, 5
    v_readlane_b32 s71, v29, 6
    v_readlane_b32 s74, v29, 7
    s_lshl_b32 s64, s39, 5
    s_add_u32 s64, s64, 6291456
    v_perm_b32 v202, v163, v162, v11
    v_mul_f32 v34, s65, v36
    v_mul_f32 v33, s66, v37
    v_mfma_f32_16x16x32_bf16 v[92:95], v[128:131], v[188:191], 0
    v_perm_b32 v203, v163, v162, v12
    v_fmac_f32 v34, s67, v38
    v_fmac_f32 v33, s68, v39
    v_perm_b32 v212, v185, v184, v9
    v_mfma_f32_16x16x32_bf16 v[88:91], v[200:203], v[224:227], v[88:91]
    v_fmac_f32 v34, s69, v40
    v_fmac_f32 v33, s70, v41
    v_perm_b32 v213, v185, v184, v10
    v_fmac_f32 v34, s71, v42
    v_fmac_f32 v33, s74, v43
    s_waitcnt lgkmcnt(2)
    v_mfma_f32_16x16x32_bf16 v[92:95], v[132:135], v[108:111], v[92:95]
    ds_read_b64 v[160:161], v19 offset:256
    v_perm_b32 v214, v185, v184, v11
    v_add_f32 v34, v34, v33
    s_cmp_eq_u32 s43, 0
    s_cbranch_scc1 recurr_f2_16
    buffer_store_dwordx2 v[34:35], v32, s[32:35], s64 offen sc1
recurr_f2_16:
    v_perm_b32 v215, v185, v184, v12
    s_nop 1
    v_mfma_f32_16x16x32_bf16 v[88:91], v[212:215], v[228:231], v[88:91]
    ds_read_b128 v[36:39], v21 offset:3776
    v_perm_b32 v40, v187, v186, v9
    v_perm_b32 v41, v187, v186, v10
    v_mfma_f32_16x16x32_bf16 v[92:95], v[136:139], v[196:199], v[92:95]
    v_perm_b32 v42, v187, v186, v11
    s_waitcnt lgkmcnt(2)
    v_mfma_f32_16x16x32_bf16 v[92:95], v[140:143], v[208:211], v[92:95]
    v_perm_b32 v43, v187, v186, v12
    v_perm_b32 v216, v205, v204, v13
    s_nop 0
    v_mfma_f32_16x16x32_bf16 v[88:91], v[40:43], v[232:235], v[88:91]
    v_perm_b32 v217, v205, v204, v14
    v_mfma_f32_16x16x32_bf16 v[92:95], v[144:147], v[60:63], v[92:95]
    v_perm_b32 v218, v205, v204, v15
    v_perm_b32 v219, v205, v204, v16
    s_nop 3
    ds_write_b128 v22, v[88:91] offset:10240
    s_waitcnt lgkmcnt(1)
    v_mfma_f32_16x16x32_bf16 v[96:99], v[128:131], v[36:39], 0
    s_cmp_eq_u32 s75, 0
    s_cbranch_scc0 recurr_nf_18
    v_perm_b32 v184, v161, v160, v9
    v_perm_b32 v185, v161, v160, v10
    v_perm_b32 v186, v161, v160, v11
    v_perm_b32 v187, v161, v160, v12
    v_bfi_b32 v216, v2, v184, v216
    v_bfi_b32 v217, v3, v185, v217
    v_bfi_b32 v218, v4, v186, v218
    v_bfi_b32 v219, v5, v187, v219
recurr_nf_18:
    v_mfma_f32_16x16x32_bf16 v[92:95], v[148:151], v[100:103], v[92:95]
    ds_read_b128 v[252:255], v21 offset:3712
    s_waitcnt lgkmcnt(1)
    s_barrier
    ds_read2st64_b32 v[28:29], v23 offset0:0 offset1:5
    ds_read2st64_b32 v[30:31], v23 offset0:10 offset1:15
    ds_read2st64_b32 v[32:33], v23 offset0:20 offset1:25
    ds_read2st64_b32 v[34:35], v23 offset0:30 offset1:35
    s_waitcnt lgkmcnt(4)
    v_mfma_f32_16x16x32_bf16 v[96:99], v[132:135], v[252:255], v[96:99]
    ds_read_b128 v[128:131], v21 offset:3648
    ds_read_b128 v[36:39], v20 offset:16
    v_mfma_f32_16x16x32_bf16 v[92:95], v[152:155], v[104:107], v[92:95]
    v_perm_b32 v160, v207, v206, v13
    v_perm_b32 v161, v207, v206, v14
    s_waitcnt lgkmcnt(1)
    v_mfma_f32_16x16x32_bf16 v[96:99], v[136:139], v[128:131], v[96:99]
    ds_read_b128 v[132:135], v21 offset:3584
    v_perm_b32 v162, v207, v206, v15
    s_cmp_eq_u32 s51, 0
    s_cselect_b32 s66, 0, 3
    s_lshl_b32 s65, s66, 18
    s_sub_u32 s64, s60, s65
    v_cmp_ne_u32 s[68:69], s64, v24
    v_pk_add_f32 v[28:29], v[28:29], v[32:33]
    v_mfma_f32_16x16x32_bf16 v[92:95], v[156:159], v[112:115], v[92:95]
    v_perm_b32 v163, v207, v206, v16
    s_waitcnt lgkmcnt(1)
    v_perm_b32 v184, v37, v36, v13
    v_pk_add_f32 v[30:31], v[30:31], v[34:35]
    v_pk_fma_f32 v[32:33], v[28:29], v[68:69], v[72:73]
    s_waitcnt lgkmcnt(0)
    v_mfma_f32_16x16x32_bf16 v[96:99], v[140:143], v[132:135], v[96:99]
    ds_read_b128 v[128:131], v21 offset:3264
    v_perm_b32 v185, v37, v36, v14
    v_pk_fma_f32 v[34:35], v[30:31], v[70:71], v[74:75]
    v_cvt_pk_bf16_f32 v44, v32, v33
    v_mfma_f32_16x16x32_bf16 v[92:95], v[116:119], v[236:239], v[92:95]
    ds_read_b128 v[136:139], v21 offset:3200
    v_perm_b32 v186, v37, v36, v15
    v_perm_b32 v187, v37, v36, v16
    v_cvt_pk_bf16_f32 v45, v34, v35
    s_mov_b64 exec, s[68:69]
    buffer_store_dwordx2 v[44:45], v24, s[28:31], s65 offen
    s_mov_b64 exec, -1
    s_waitcnt lgkmcnt(1)
    v_mfma_f32_16x16x32_bf16 v[96:99], v[144:147], v[128:131], v[96:99]
    ds_read_b128 v[132:135], v20 offset:64
    ds_read_b128 v[140:143], v21 offset:3136
    v_perm_b32 v204, v39, v38, v13
    v_mfma_f32_16x16x32_bf16 v[92:95], v[64:67], v[240:243], v[92:95]
    v_perm_b32 v205, v39, v38, v14
    v_perm_b32 v206, v39, v38, v15
    s_waitcnt lgkmcnt(2)
    v_mfma_f32_16x16x32_bf16 v[96:99], v[148:151], v[136:139], v[96:99]
    ds_read_b128 v[128:131], v21 offset:3072
    v_perm_b32 v207, v39, v38, v16
    v_mfma_f32_16x16x32_bf16 v[92:95], v[172:175], v[244:247], v[92:95]
    s_waitcnt lgkmcnt(2)
    v_perm_b32 v252, v133, v132, v13
    v_perm_b32 v253, v133, v132, v14
    s_waitcnt lgkmcnt(1)
    v_mfma_f32_16x16x32_bf16 v[96:99], v[152:155], v[140:143], v[96:99]
    ds_read_b128 v[136:139], v20 offset:80
    ds_read_b128 v[144:147], v21 offset:2752
    v_perm_b32 v254, v133, v132, v15
    v_mfma_f32_16x16x32_bf16 v[92:95], v[180:183], v[248:251], v[92:95]
    v_perm_b32 v255, v133, v132, v16
    v_perm_b32 v36, v135, v134, v13
    s_waitcnt lgkmcnt(2)
    v_mfma_f32_16x16x32_bf16 v[96:99], v[156:159], v[128:131], v[96:99]
    ds_read_b128 v[140:143], v21 offset:2688
    v_perm_b32 v37, v135, v134, v14
    v_mfma_f32_16x16x32_bf16 v[92:95], v[192:195], v[164:167], v[92:95]
    v_perm_b32 v38, v135, v134, v15
    v_perm_b32 v39, v135, v134, v16
    s_waitcnt lgkmcnt(1)
    v_mfma_f32_16x16x32_bf16 v[96:99], v[116:119], v[144:147], v[96:99]
    ds_read_b128 v[128:131], v21 offset:2624
    ds_read_b128 v[148:151], v20 offset:128
    v_perm_b32 v152, v137, v136, v13
    v_mfma_f32_16x16x32_bf16 v[92:95], v[200:203], v[168:171], v[92:95]
    v_perm_b32 v153, v137, v136, v14
    v_perm_b32 v154, v137, v136, v15
    s_waitcnt lgkmcnt(2)
    v_mfma_f32_16x16x32_bf16 v[96:99], v[64:67], v[140:143], v[96:99]
    ds_read_b128 v[132:135], v21 offset:2560
    v_perm_b32 v155, v137, v136, v16
    v_mfma_f32_16x16x32_bf16 v[92:95], v[212:215], v[52:55], v[92:95]
    v_perm_b32 v116, v139, v138, v13
    v_perm_b32 v117, v139, v138, v14
    s_waitcnt lgkmcnt(1)
    v_mfma_f32_16x16x32_bf16 v[96:99], v[172:175], v[128:131], v[96:99]
    v_perm_b32 v118, v139, v138, v15
    v_mfma_f32_16x16x32_bf16 v[92:95], v[40:43], v[176:179], v[92:95]
    ds_read_b128 v[140:143], v20 offset:144
    v_perm_b32 v119, v139, v138, v16
    v_perm_b32 v64, v149, v148, v13
    s_waitcnt lgkmcnt(1)
    v_mfma_f32_16x16x32_bf16 v[96:99], v[180:183], v[132:135], v[96:99]
    v_perm_b32 v65, v149, v148, v14
    v_mfma_f32_16x16x32_bf16 v[92:95], v[216:219], v[220:223], v[92:95]
    v_perm_b32 v66, v149, v148, v15
    v_perm_b32 v67, v149, v148, v16
    v_mfma_f32_16x16x32_bf16 v[96:99], v[192:195], v[188:191], v[96:99]
    v_perm_b32 v156, v151, v150, v13
    v_mfma_f32_16x16x32_bf16 v[92:95], v[160:163], v[224:227], v[92:95]
    v_perm_b32 v157, v151, v150, v14
    v_perm_b32 v158, v151, v150, v15
    v_mfma_f32_16x16x32_bf16 v[96:99], v[200:203], v[108:111], v[96:99]
    ds_read_b128 v[172:175], v20 offset:192
    v_perm_b32 v159, v151, v150, v16
    v_mfma_f32_16x16x32_bf16 v[92:95], v[184:187], v[228:231], v[92:95]
    s_waitcnt lgkmcnt(1)
    v_perm_b32 v180, v141, v140, v13
    v_perm_b32 v181, v141, v140, v14
    v_mfma_f32_16x16x32_bf16 v[96:99], v[212:215], v[196:199], v[96:99]
    v_perm_b32 v182, v141, v140, v15
    v_mfma_f32_16x16x32_bf16 v[92:95], v[204:207], v[232:235], v[92:95]
    v_perm_b32 v183, v141, v140, v16
    v_perm_b32 v108, v143, v142, v13
    v_mfma_f32_16x16x32_bf16 v[96:99], v[40:43], v[208:211], v[96:99]
    v_perm_b32 v109, v143, v142, v14
    s_nop 3
    ds_write_b128 v22, v[92:95] offset:20480
    v_mfma_f32_16x16x32_bf16 v[96:99], v[216:219], v[60:63], v[96:99]
    ds_read_b128 v[188:191], v20 offset:208
    v_perm_b32 v110, v143, v142, v15
    v_perm_b32 v111, v143, v142, v16
    v_mfma_f32_16x16x32_bf16 v[96:99], v[160:163], v[100:103], v[96:99]
    s_waitcnt lgkmcnt(2)
    v_perm_b32 v40, v173, v172, v13
    s_cmp_eq_u32 s77, 0
    s_cbranch_scc1 recurr_pl_20
    v_mov_b32 v148, 0
    v_mov_b32 v149, s42
    v_mov_b32 v150, 0
    v_mov_b32 v151, s42
    s_mul_i32 s64, s37, 5504
    s_add_u32 s64, s64, 6291456
    v_lshlrev_b32 v46, 4, v1
    buffer_load_dwordx4 v[128:131], v46, s[32:35], s64 offen offset:0 sc1
    buffer_load_dwordx4 v[132:135], v46, s[32:35], s64 offen offset:1024 sc1
    buffer_load_dwordx4 v[136:139], v46, s[32:35], s64 offen offset:2048 sc1
    buffer_load_dwordx4 v[140:143], v46, s[32:35], s64 offen offset:3072 sc1
    s_add_u32 s64, s64, 4096
    buffer_load_dwordx4 v[144:147], v46, s[32:35], s64 offen sc1
    s_mov_b64 exec, 0xffffff
    buffer_load_dwordx4 v[148:151], v46, s[32:35], s64 offen offset:1024 sc1
    s_mov_b64 exec, -1
    v_bfe_u32 v120, v1, 2, 1
    v_and_b32 v121, 1, v1
    v_lshl_add_u32 v120, v121, 1, v120
    v_mov_b32 v121, 0
    v_mov_b32 v122, 0
    v_lshl_add_u32 v123, v120, 1, s60
    v_lshl_add_u32 v124, v120, 1, s36
    global_load_short_d16_hi v121, v123, s[4:5]
    global_load_short_d16_hi v122, v124, s[16:17]
    s_ashr_i32 s64, s62, 31
    s_not_b32 s64, s64
    s_or_b32 s64, s64, 0x80000000
    s_xor_b32 s64, s64, s62
    s_and_b32 s64, s64, 0xffff0000
    v_mov_b32 v126, s64
    s_and_b32 s64, s61, 0xffff0000
    v_mul_f32 v126, s72, v126
    v_rcp_f32 v127, s64
    v_exp_f32 v126, v126
    s_lshr_b32 s64, s63, 1
    s_mul_i32 s64, s64, 10240
    s_bfe_u32 s67, s60, 0x2000c
    s_mul_i32 s67, s67, 288
    v_add_f32 v126, 1.0, v126
    s_add_u32 s64, s64, s67
    s_bfe_u32 s67, s60, 0x4000e
    s_lshl_b32 s67, s67, 4
    v_rcp_f32 v126, v126
    s_add_u32 s64, s64, s67
    s_bfe_u32 s67, s60, 0x2000a
    s_lshl_b32 s67, s67, 2
    s_add_u32 s64, s64, s67
    v_mul_u32_u24 v125, 1280, v120
    v_add_u32 v125, s64, v125
    v_cvt_pk_bf16_f32 v126, v126, v126
    v_and_b32 v126, 0xffff0000, v126
recurr_pl_20:
    s_waitcnt lgkmcnt(1)
    s_barrier
    s_cmp_eq_u32 s51, 0
    s_cbranch_scc0 recurr_ep_21
    ds_read2st64_b32 v[28:29], v23 offset0:80 offset1:85
    ds_read2st64_b32 v[30:31], v23 offset0:90 offset1:95
    ds_read2st64_b32 v[32:33], v23 offset0:100 offset1:105
    ds_read2st64_b32 v[34:35], v23 offset0:110 offset1:115
    s_cmp_eq_u32 s51, 0
    s_cselect_b32 s66, 4, 4
    s_lshl_b32 s65, s66, 18
    s_sub_u32 s64, s60, s65
    v_cmp_ne_u32 s[68:69], s64, v24
    s_waitcnt lgkmcnt(0)
    v_pk_add_f32 v[28:29], v[28:29], v[32:33]
    v_pk_add_f32 v[30:31], v[30:31], v[34:35]
    v_pk_fma_f32 v[32:33], v[28:29], v[76:77], v[80:81]
    v_pk_fma_f32 v[34:35], v[30:31], v[78:79], v[82:83]
    v_cvt_pk_bf16_f32 v44, v32, v33
    v_cvt_pk_bf16_f32 v45, v34, v35
    s_mov_b64 exec, s[68:69]
    buffer_store_dwordx2 v[44:45], v24, s[28:31], s65 offen
    s_mov_b64 exec, -1
recurr_ep_21:
    v_mfma_f32_16x16x32_bf16 v[96:99], v[184:187], v[104:107], v[96:99]
    v_perm_b32 v41, v173, v172, v14
    v_perm_b32 v42, v173, v172, v15
    v_mfma_f32_16x16x32_bf16 v[96:99], v[204:207], v[112:115], v[96:99]
    v_perm_b32 v43, v173, v172, v16
    v_mfma_f32_16x16x32_bf16 v[96:99], v[252:255], v[236:239], v[96:99]
    v_perm_b32 v60, v175, v174, v13
    v_perm_b32 v61, v175, v174, v14
    v_mfma_f32_16x16x32_bf16 v[96:99], v[36:39], v[240:243], v[96:99]
    v_perm_b32 v62, v175, v174, v15
    v_mfma_f32_16x16x32_bf16 v[96:99], v[152:155], v[244:247], v[96:99]
    v_perm_b32 v63, v175, v174, v16
    s_waitcnt lgkmcnt(0)
    v_perm_b32 v100, v189, v188, v13
    v_mfma_f32_16x16x32_bf16 v[96:99], v[116:119], v[248:251], v[96:99]
    v_perm_b32 v101, v189, v188, v14
    v_mfma_f32_16x16x32_bf16 v[96:99], v[64:67], v[164:167], v[96:99]
    v_perm_b32 v102, v189, v188, v15
    v_perm_b32 v103, v189, v188, v16
    v_mfma_f32_16x16x32_bf16 v[96:99], v[156:159], v[168:171], v[96:99]
    v_perm_b32 v36, v191, v190, v13
    v_mfma_f32_16x16x32_bf16 v[96:99], v[180:183], v[52:55], v[96:99]
    v_perm_b32 v37, v191, v190, v14
    v_perm_b32 v38, v191, v190, v15
    v_mfma_f32_16x16x32_bf16 v[96:99], v[108:111], v[176:179], v[96:99]
    v_perm_b32 v39, v191, v190, v16
    v_mfma_f32_16x16x32_bf16 v[96:99], v[40:43], v[220:223], v[96:99]
    v_mfma_f32_16x16x32_bf16 v[96:99], v[60:63], v[224:227], v[96:99]
    v_mfma_f32_16x16x32_bf16 v[96:99], v[100:103], v[228:231], v[96:99]
    v_mfma_f32_16x16x32_bf16 v[96:99], v[36:39], v[232:235], v[96:99]
    s_nop 7
    ds_write_b128 v22, v[96:99] offset:30720
    s_waitcnt lgkmcnt(0)
    s_barrier
    s_cmp_eq_u32 s51, 1
    s_cbranch_scc0 recurr_ep_23
    ds_read2st64_b32 v[28:29], v23 offset0:80 offset1:85
    ds_read2st64_b32 v[30:31], v23 offset0:90 offset1:95
    ds_read2st64_b32 v[32:33], v23 offset0:100 offset1:105
    ds_read2st64_b32 v[34:35], v23 offset0:110 offset1:115
    s_cmp_eq_u32 s51, 0
    s_cselect_b32 s66, 7, 7
    s_lshl_b32 s65, s66, 18
    s_sub_u32 s64, s60, s65
    v_cmp_ne_u32 s[68:69], s64, v24
    s_waitcnt lgkmcnt(0)
    v_pk_add_f32 v[28:29], v[28:29], v[32:33]
    v_pk_add_f32 v[30:31], v[30:31], v[34:35]
    v_pk_fma_f32 v[32:33], v[28:29], v[76:77], v[80:81]
    v_pk_fma_f32 v[34:35], v[30:31], v[78:79], v[82:83]
    v_cvt_pk_bf16_f32 v44, v32, v33
    v_cvt_pk_bf16_f32 v45, v34, v35
    s_mov_b64 exec, s[68:69]
    buffer_store_dwordx2 v[44:45], v24, s[28:31], s65 offen
    s_mov_b64 exec, -1
recurr_ep_23:
    s_branch recurr_fin_15
recurr_h1_14:
    ds_read_b32 v28, v30 offset:26368
    ds_read_b32 v29, v30 offset:34816
    ds_read_b128 v[52:55], v21 offset:704
    ds_read2_b64 v[60:63], v19 offset0:0 offset1:2
    ds_read_b128 v[64:67], v18 offset:256
    ds_read_b128 v[100:103], v21 offset:640
    s_waitcnt lgkmcnt(3)
    v_mfma_f32_16x16x32_bf16 v[84:87], v[128:131], v[52:55], 0
    ds_read_b128 v[104:107], v21 offset:576
    ds_read_b128 v[108:111], v21 offset:512
    v_mfma_f32_16x16x32_bf16 v[88:91], v[128:131], v[236:239], 0
    ds_read2_b64 v[112:115], v19 offset0:4 offset1:6
    s_waitcnt lgkmcnt(5)
    v_perm_b32 v116, v61, v60, v9
    v_perm_b32 v117, v61, v60, v10
    v_perm_b32 v118, v61, v60, v11
    s_waitcnt lgkmcnt(3)
    v_mfma_f32_16x16x32_bf16 v[84:87], v[132:135], v[100:103], v[84:87]
    v_perm_b32 v119, v61, v60, v12
    v_add_f32 v28, v28, v29
    s_cmp_eq_u32 s75, 0
    s_cbranch_scc0 recurr_nf_26
    v_perm_b32 v163, v65, v64, v7
    v_perm_b32 v162, v65, v64, v8
    v_perm_b32 v161, v66, v65, v7
    v_perm_b32 v160, v66, v65, v8
    v_bfi_b32 v116, v2, v160, v116
    v_bfi_b32 v117, v3, v161, v117
    v_bfi_b32 v118, v4, v162, v118
    v_bfi_b32 v119, v5, v163, v119
recurr_nf_26:
    v_mfma_f32_16x16x32_bf16 v[88:91], v[132:135], v[240:243], v[88:91]
    s_waitcnt lgkmcnt(1)
    v_mfma_f32_16x16x32_bf16 v[84:87], v[136:139], v[104:107], v[84:87]
    v_mov_b32 v29, v28
    v_perm_b32 v64, v63, v62, v9
    s_nop 0
    v_permlane32_swap_b32 v28, v29
    v_mfma_f32_16x16x32_bf16 v[88:91], v[136:139], v[244:247], v[88:91]
    v_perm_b32 v65, v63, v62, v10
    v_add_f32 v28, v28, v29
    v_perm_b32 v66, v63, v62, v11
    v_mfma_f32_16x16x32_bf16 v[84:87], v[140:143], v[108:111], v[84:87]
    ds_read2_b64 v[160:163], v19 offset0:16 offset1:18
    v_mov_b32 v29, v28
    v_perm_b32 v67, v63, v62, v12
    s_nop 0
    v_permlane16_swap_b32 v28, v29
    v_mfma_f32_16x16x32_bf16 v[88:91], v[140:143], v[248:251], v[88:91]
    s_waitcnt lgkmcnt(1)
    v_perm_b32 v164, v113, v112, v9
    v_add_f32 v28, v28, v29
    v_perm_b32 v165, v113, v112, v10
    v_mfma_f32_16x16x32_bf16 v[84:87], v[144:147], v[220:223], v[84:87]
    v_cvt_pk_bf16_f32 v28, v28, v28
    v_perm_b32 v166, v113, v112, v11
    v_and_b32 v28, 0xffff0000, v28
    v_mfma_f32_16x16x32_bf16 v[88:91], v[144:147], v[52:55], v[88:91]
    v_perm_b32 v167, v113, v112, v12
    v_mul_f32 v29, s72, v28
    v_perm_b32 v60, v115, v114, v9
    v_mfma_f32_16x16x32_bf16 v[84:87], v[148:151], v[224:227], v[84:87]
    v_exp_f32 v29, v29
    v_perm_b32 v61, v115, v114, v10
    v_add_f32 v29, 1.0, v29
    v_mfma_f32_16x16x32_bf16 v[88:91], v[148:151], v[100:103], v[88:91]
    ds_read2_b64 v[168:171], v19 offset0:20 offset1:22
    v_perm_b32 v62, v115, v114, v11
    v_rcp_f32 v29, v29
    v_perm_b32 v63, v115, v114, v12
    v_mfma_f32_16x16x32_bf16 v[84:87], v[152:155], v[228:231], v[84:87]
    v_mul_f32 v29, v29, v28
    s_waitcnt lgkmcnt(1)
    v_perm_b32 v172, v161, v160, v9
    v_cvt_pk_bf16_f32 v29, v29, v29
    v_mfma_f32_16x16x32_bf16 v[88:91], v[152:155], v[104:107], v[88:91]
    v_perm_b32 v173, v161, v160, v10
    v_and_b32 v29, 0xffff0000, v29
    v_perm_b32 v174, v161, v160, v11
    v_mfma_f32_16x16x32_bf16 v[84:87], v[156:159], v[232:235], v[84:87]
    ds_read_b128 v[112:115], v21 offset:2752
    v_mul_f32_dpp v29, v28, v29 row_ror:8 row_mask:0xf bank_mask:0xf
    v_perm_b32 v175, v161, v160, v12
    v_cvt_pk_bf16_f32 v29, v29, v29
    v_mfma_f32_16x16x32_bf16 v[88:91], v[156:159], v[108:111], v[88:91]
    ds_read_b128 v[176:179], v21 offset:2688
    v_perm_b32 v180, v163, v162, v9
    v_and_b32 v29, 0xffff0000, v29
    v_perm_b32 v181, v163, v162, v10
    ds_write_b128 v22, v[84:87] offset:0
    v_mfma_f32_16x16x32_bf16 v[88:91], v[116:119], v[220:223], v[88:91]
    ds_read_b128 v[184:187], v20 offset:0
    ds_read_b128 v[188:191], v21 offset:2624
    v_readlane_b32 s65, v29, 0
    v_readlane_b32 s66, v29, 1
    v_readlane_b32 s67, v29, 2
    v_readlane_b32 s68, v29, 3
    v_readlane_b32 s69, v29, 4
    v_readlane_b32 s70, v29, 5
    v_readlane_b32 s71, v29, 6
    v_readlane_b32 s74, v29, 7
    s_lshl_b32 s64, s39, 5
    s_add_u32 s64, s64, 6291456
    v_perm_b32 v182, v163, v162, v11
    v_mul_f32 v34, s65, v36
    v_mul_f32 v33, s66, v37
    v_mfma_f32_16x16x32_bf16 v[88:91], v[64:67], v[224:227], v[88:91]
    ds_read_b128 v[192:195], v21 offset:2560
    v_perm_b32 v183, v163, v162, v12
    v_fmac_f32 v34, s67, v38
    v_fmac_f32 v33, s68, v39
    s_waitcnt lgkmcnt(6)
    v_perm_b32 v196, v169, v168, v9
    v_mfma_f32_16x16x32_bf16 v[88:91], v[164:167], v[228:231], v[88:91]
    ds_read_b128 v[200:203], v21 offset:2240
    v_fmac_f32 v34, s69, v40
    v_fmac_f32 v33, s70, v41
    v_perm_b32 v197, v169, v168, v10
    v_fmac_f32 v34, s71, v42
    v_fmac_f32 v33, s74, v43
    v_mfma_f32_16x16x32_bf16 v[88:91], v[60:63], v[232:235], v[88:91]
    ds_read_b64 v[160:161], v19 offset:256
    ds_read_b128 v[204:207], v21 offset:3264
    v_perm_b32 v198, v169, v168, v11
    v_add_f32 v34, v34, v33
    s_cmp_eq_u32 s43, 0
    s_cbranch_scc1 recurr_f2_25
    buffer_store_dwordx2 v[34:35], v32, s[32:35], s64 offen sc1
recurr_f2_25:
    v_perm_b32 v199, v169, v168, v12
    s_waitcnt lgkmcnt(4)
    v_mfma_f32_16x16x32_bf16 v[92:95], v[128:131], v[112:115], 0
    ds_read_b128 v[36:39], v21 offset:2176
    v_perm_b32 v40, v171, v170, v9
    v_perm_b32 v41, v171, v170, v10
    ds_write_b128 v22, v[88:91] offset:10240
    v_mfma_f32_16x16x32_bf16 v[92:95], v[132:135], v[176:179], v[92:95]
    ds_read_b128 v[208:211], v21 offset:3200
    v_perm_b32 v42, v171, v170, v11
    v_mfma_f32_16x16x32_bf16 v[92:95], v[136:139], v[188:191], v[92:95]
    ds_read_b128 v[212:215], v21 offset:2112
    v_perm_b32 v43, v171, v170, v12
    v_perm_b32 v216, v185, v184, v13
    s_waitcnt lgkmcnt(2)
    s_barrier
    ds_read2st64_b32 v[28:29], v23 offset0:0 offset1:5
    ds_read2st64_b32 v[30:31], v23 offset0:10 offset1:15
    ds_read2st64_b32 v[32:33], v23 offset0:20 offset1:25
    ds_read2st64_b32 v[34:35], v23 offset0:30 offset1:35
    v_mfma_f32_16x16x32_bf16 v[92:95], v[140:143], v[192:195], v[92:95]
    v_perm_b32 v217, v185, v184, v14
    v_mfma_f32_16x16x32_bf16 v[92:95], v[144:147], v[200:203], v[92:95]
    v_perm_b32 v218, v185, v184, v15
    v_perm_b32 v219, v185, v184, v16
    v_mfma_f32_16x16x32_bf16 v[96:99], v[128:131], v[204:207], 0
    s_cmp_eq_u32 s75, 0
    s_cbranch_scc0 recurr_nf_28
    v_perm_b32 v168, v161, v160, v9
    v_perm_b32 v169, v161, v160, v10
    v_perm_b32 v170, v161, v160, v11
    v_perm_b32 v171, v161, v160, v12
    v_bfi_b32 v216, v2, v168, v216
    v_bfi_b32 v217, v3, v169, v217
    v_bfi_b32 v218, v4, v170, v218
    v_bfi_b32 v219, v5, v171, v219
recurr_nf_28:
    s_cmp_eq_u32 s51, 0
    s_cselect_b32 s66, 1, 2
    s_lshl_b32 s65, s66, 18
    s_sub_u32 s64, s60, s65
    v_cmp_ne_u32 s[68:69], s64, v24
    s_waitcnt lgkmcnt(0)
    v_pk_add_f32 v[28:29], v[28:29], v[32:33]
    v_mfma_f32_16x16x32_bf16 v[92:95], v[148:151], v[36:39], v[92:95]
    v_pk_add_f32 v[30:31], v[30:31], v[34:35]
    v_pk_fma_f32 v[32:33], v[28:29], v[68:69], v[72:73]
    v_mfma_f32_16x16x32_bf16 v[96:99], v[132:135], v[208:211], v[96:99]
    ds_read_b128 v[128:131], v21 offset:3136
    ds_read_b128 v[160:163], v20 offset:16
    v_pk_fma_f32 v[34:35], v[30:31], v[70:71], v[74:75]
    v_cvt_pk_bf16_f32 v44, v32, v33
    v_mfma_f32_16x16x32_bf16 v[92:95], v[152:155], v[212:215], v[92:95]
    ds_read_b128 v[168:171], v21 offset:2048
    v_perm_b32 v204, v187, v186, v13
    v_perm_b32 v205, v187, v186, v14
    v_cvt_pk_bf16_f32 v45, v34, v35
    s_mov_b64 exec, s[68:69]
    buffer_store_dwordx2 v[44:45], v24, s[28:31], s65 offen
    s_mov_b64 exec, -1
    s_waitcnt lgkmcnt(2)
    v_mfma_f32_16x16x32_bf16 v[96:99], v[136:139], v[128:131], v[96:99]
    ds_read_b128 v[132:135], v21 offset:3072
    v_perm_b32 v206, v187, v186, v15
    s_waitcnt lgkmcnt(1)
    v_mfma_f32_16x16x32_bf16 v[92:95], v[156:159], v[168:171], v[92:95]
    v_perm_b32 v207, v187, v186, v16
    v_perm_b32 v208, v161, v160, v13
    s_waitcnt lgkmcnt(0)
    v_mfma_f32_16x16x32_bf16 v[96:99], v[140:143], v[132:135], v[96:99]
    ds_read_b128 v[128:131], v21 offset:1728
    v_perm_b32 v209, v161, v160, v14
    s_waitcnt lgkmcnt(0)
    v_mfma_f32_16x16x32_bf16 v[92:95], v[116:119], v[128:131], v[92:95]
    ds_read_b128 v[136:139], v21 offset:1664
    v_perm_b32 v210, v161, v160, v15
    v_perm_b32 v211, v161, v160, v16
    v_mfma_f32_16x16x32_bf16 v[96:99], v[144:147], v[112:115], v[96:99]
    ds_read_b128 v[132:135], v20 offset:64
    ds_read_b128 v[140:143], v21 offset:1600
    v_perm_b32 v184, v163, v162, v13
    s_waitcnt lgkmcnt(2)
    v_mfma_f32_16x16x32_bf16 v[92:95], v[64:67], v[136:139], v[92:95]
    v_perm_b32 v185, v163, v162, v14
    v_perm_b32 v186, v163, v162, v15
    v_mfma_f32_16x16x32_bf16 v[96:99], v[148:151], v[176:179], v[96:99]
    ds_read_b128 v[144:147], v21 offset:1536
    v_perm_b32 v187, v163, v162, v16
    s_waitcnt lgkmcnt(1)
    v_mfma_f32_16x16x32_bf16 v[92:95], v[164:167], v[140:143], v[92:95]
    v_perm_b32 v112, v133, v132, v13
    v_perm_b32 v113, v133, v132, v14
    v_mfma_f32_16x16x32_bf16 v[96:99], v[152:155], v[188:191], v[96:99]
    ds_read_b128 v[148:151], v20 offset:80
    v_perm_b32 v114, v133, v132, v15
    s_waitcnt lgkmcnt(1)
    v_mfma_f32_16x16x32_bf16 v[92:95], v[60:63], v[144:147], v[92:95]
    v_perm_b32 v115, v133, v132, v16
    v_perm_b32 v160, v135, v134, v13
    v_mfma_f32_16x16x32_bf16 v[96:99], v[156:159], v[192:195], v[96:99]
    v_perm_b32 v161, v135, v134, v14
    v_mfma_f32_16x16x32_bf16 v[92:95], v[172:175], v[236:239], v[92:95]
    ds_read_b128 v[152:155], v20 offset:128
    v_perm_b32 v162, v135, v134, v15
    v_perm_b32 v163, v135, v134, v16
    v_mfma_f32_16x16x32_bf16 v[96:99], v[116:119], v[200:203], v[96:99]
    s_waitcnt lgkmcnt(1)
    v_perm_b32 v156, v149, v148, v13
    v_mfma_f32_16x16x32_bf16 v[92:95], v[180:183], v[240:243], v[92:95]
    v_perm_b32 v157, v149, v148, v14
    v_perm_b32 v158, v149, v148, v15
    v_mfma_f32_16x16x32_bf16 v[96:99], v[64:67], v[36:39], v[96:99]
    v_perm_b32 v159, v149, v148, v16
    v_mfma_f32_16x16x32_bf16 v[92:95], v[196:199], v[244:247], v[92:95]
    v_perm_b32 v116, v151, v150, v13
    v_perm_b32 v117, v151, v150, v14
    v_mfma_f32_16x16x32_bf16 v[96:99], v[164:167], v[212:215], v[96:99]
    v_perm_b32 v118, v151, v150, v15
    v_mfma_f32_16x16x32_bf16 v[92:95], v[40:43], v[248:251], v[92:95]
    ds_read_b128 v[132:135], v20 offset:144
    v_perm_b32 v119, v151, v150, v16
    s_waitcnt lgkmcnt(1)
    v_perm_b32 v36, v153, v152, v13
    v_mfma_f32_16x16x32_bf16 v[96:99], v[60:63], v[168:171], v[96:99]
    v_perm_b32 v37, v153, v152, v14
    v_mfma_f32_16x16x32_bf16 v[92:95], v[216:219], v[52:55], v[92:95]
    v_perm_b32 v38, v153, v152, v15
    v_perm_b32 v39, v153, v152, v16
    v_mfma_f32_16x16x32_bf16 v[96:99], v[172:175], v[128:131], v[96:99]
    v_perm_b32 v60, v155, v154, v13
    v_mfma_f32_16x16x32_bf16 v[92:95], v[204:207], v[100:103], v[92:95]
    v_perm_b32 v61, v155, v154, v14
    v_perm_b32 v62, v155, v154, v15
    v_mfma_f32_16x16x32_bf16 v[96:99], v[180:183], v[136:139], v[96:99]
    v_perm_b32 v63, v155, v154, v16
    v_mfma_f32_16x16x32_bf16 v[92:95], v[208:211], v[104:107], v[92:95]
    s_waitcnt lgkmcnt(0)
    v_perm_b32 v64, v133, v132, v13
    v_perm_b32 v65, v133, v132, v14
    v_mfma_f32_16x16x32_bf16 v[96:99], v[196:199], v[140:143], v[96:99]
    v_perm_b32 v66, v133, v132, v15
    v_mfma_f32_16x16x32_bf16 v[92:95], v[184:187], v[108:111], v[92:95]
    v_perm_b32 v67, v133, v132, v16
    v_perm_b32 v152, v135, v134, v13
    v_mfma_f32_16x16x32_bf16 v[96:99], v[40:43], v[144:147], v[96:99]
    v_perm_b32 v153, v135, v134, v14
    v_mfma_f32_16x16x32_bf16 v[92:95], v[112:115], v[220:223], v[92:95]
    v_perm_b32 v154, v135, v134, v15
    v_perm_b32 v155, v135, v134, v16
    v_mfma_f32_16x16x32_bf16 v[96:99], v[216:219], v[236:239], v[96:99]
    s_cmp_eq_u32 s77, 0
    s_cbranch_scc1 recurr_pl_29
    v_mov_b32 v148, 0
    v_mov_b32 v149, s42
    v_mov_b32 v150, 0
    v_mov_b32 v151, s42
    s_mul_i32 s64, s37, 5504
    s_add_u32 s64, s64, 6291456
    v_lshlrev_b32 v46, 4, v1
    buffer_load_dwordx4 v[128:131], v46, s[32:35], s64 offen offset:0 sc1
    buffer_load_dwordx4 v[132:135], v46, s[32:35], s64 offen offset:1024 sc1
    buffer_load_dwordx4 v[136:139], v46, s[32:35], s64 offen offset:2048 sc1
    buffer_load_dwordx4 v[140:143], v46, s[32:35], s64 offen offset:3072 sc1
    s_add_u32 s64, s64, 4096
    buffer_load_dwordx4 v[144:147], v46, s[32:35], s64 offen sc1
    s_mov_b64 exec, 0xffffff
    buffer_load_dwordx4 v[148:151], v46, s[32:35], s64 offen offset:1024 sc1
    s_mov_b64 exec, -1
    v_bfe_u32 v120, v1, 2, 1
    v_and_b32 v121, 1, v1
    v_lshl_add_u32 v120, v121, 1, v120
    v_mov_b32 v121, 0
    v_mov_b32 v122, 0
    v_lshl_add_u32 v123, v120, 1, s60
    v_lshl_add_u32 v124, v120, 1, s36
    global_load_short_d16_hi v121, v123, s[4:5]
    global_load_short_d16_hi v122, v124, s[16:17]
    s_ashr_i32 s64, s62, 31
    s_not_b32 s64, s64
    s_or_b32 s64, s64, 0x80000000
    s_xor_b32 s64, s64, s62
    s_and_b32 s64, s64, 0xffff0000
    v_mov_b32 v126, s64
    s_and_b32 s64, s61, 0xffff0000
    v_mul_f32 v126, s72, v126
    v_rcp_f32 v127, s64
    v_exp_f32 v126, v126
    s_lshr_b32 s64, s63, 1
    s_mul_i32 s64, s64, 10240
    s_bfe_u32 s67, s60, 0x2000c
    s_mul_i32 s67, s67, 288
    v_add_f32 v126, 1.0, v126
    s_add_u32 s64, s64, s67
    s_bfe_u32 s67, s60, 0x4000e
    s_lshl_b32 s67, s67, 4
    v_rcp_f32 v126, v126
    s_add_u32 s64, s64, s67
    s_bfe_u32 s67, s60, 0x2000a
    s_lshl_b32 s67, s67, 2
    s_add_u32 s64, s64, s67
    v_mul_u32_u24 v125, 1280, v120
    v_add_u32 v125, s64, v125
    v_cvt_pk_bf16_f32 v126, v126, v126
    v_and_b32 v126, 0xffff0000, v126
recurr_pl_29:
    v_mfma_f32_16x16x32_bf16 v[92:95], v[160:163], v[224:227], v[92:95]
    v_mfma_f32_16x16x32_bf16 v[96:99], v[204:207], v[240:243], v[96:99]
    v_mfma_f32_16x16x32_bf16 v[92:95], v[156:159], v[228:231], v[92:95]
    v_mfma_f32_16x16x32_bf16 v[96:99], v[208:211], v[244:247], v[96:99]
    v_mfma_f32_16x16x32_bf16 v[92:95], v[116:119], v[232:235], v[92:95]
    v_mfma_f32_16x16x32_bf16 v[96:99], v[184:187], v[248:251], v[96:99]
    s_nop 6
    ds_write_b128 v22, v[92:95] offset:20480
    v_mfma_f32_16x16x32_bf16 v[96:99], v[112:115], v[52:55], v[96:99]
    v_mfma_f32_16x16x32_bf16 v[96:99], v[160:163], v[100:103], v[96:99]
    s_waitcnt lgkmcnt(0)
    s_barrier
    s_cmp_eq_u32 s51, 0
    s_cbranch_scc0 recurr_ep_30
    ds_read2st64_b32 v[28:29], v23 offset0:80 offset1:85
    ds_read2st64_b32 v[30:31], v23 offset0:90 offset1:95
    ds_read2st64_b32 v[32:33], v23 offset0:100 offset1:105
    ds_read2st64_b32 v[34:35], v23 offset0:110 offset1:115
    s_cmp_eq_u32 s51, 0
    s_cselect_b32 s66, 5, 5
    s_lshl_b32 s65, s66, 18
    s_sub_u32 s64, s60, s65
    v_cmp_ne_u32 s[68:69], s64, v24
    s_waitcnt lgkmcnt(0)
    v_pk_add_f32 v[28:29], v[28:29], v[32:33]
    v_pk_add_f32 v[30:31], v[30:31], v[34:35]
    v_pk_fma_f32 v[32:33], v[28:29], v[76:77], v[80:81]
    v_pk_fma_f32 v[34:35], v[30:31], v[78:79], v[82:83]
    v_cvt_pk_bf16_f32 v44, v32, v33
    v_cvt_pk_bf16_f32 v45, v34, v35
    s_mov_b64 exec, s[68:69]
    buffer_store_dwordx2 v[44:45], v24, s[28:31], s65 offen
    s_mov_b64 exec, -1
recurr_ep_30:
    v_mfma_f32_16x16x32_bf16 v[96:99], v[156:159], v[104:107], v[96:99]
    v_mfma_f32_16x16x32_bf16 v[96:99], v[116:119], v[108:111], v[96:99]
    v_mfma_f32_16x16x32_bf16 v[96:99], v[36:39], v[220:223], v[96:99]
    v_mfma_f32_16x16x32_bf16 v[96:99], v[60:63], v[224:227], v[96:99]
    v_mfma_f32_16x16x32_bf16 v[96:99], v[64:67], v[228:231], v[96:99]
    v_mfma_f32_16x16x32_bf16 v[96:99], v[152:155], v[232:235], v[96:99]
    s_nop 7
    ds_write_b128 v22, v[96:99] offset:30720
    s_waitcnt lgkmcnt(0)
    s_barrier
    s_cmp_eq_u32 s51, 1
    s_cbranch_scc0 recurr_ep_32
    ds_read2st64_b32 v[28:29], v23 offset0:80 offset1:85
    ds_read2st64_b32 v[30:31], v23 offset0:90 offset1:95
    ds_read2st64_b32 v[32:33], v23 offset0:100 offset1:105
    ds_read2st64_b32 v[34:35], v23 offset0:110 offset1:115
    s_cmp_eq_u32 s51, 0
    s_cselect_b32 s66, 6, 6
    s_lshl_b32 s65, s66, 18
    s_sub_u32 s64, s60, s65
    v_cmp_ne_u32 s[68:69], s64, v24
    s_waitcnt lgkmcnt(0)
    v_pk_add_f32 v[28:29], v[28:29], v[32:33]
    v_pk_add_f32 v[30:31], v[30:31], v[34:35]
    v_pk_fma_f32 v[32:33], v[28:29], v[76:77], v[80:81]
    v_pk_fma_f32 v[34:35], v[30:31], v[78:79], v[82:83]
    v_cvt_pk_bf16_f32 v44, v32, v33
    v_cvt_pk_bf16_f32 v45, v34, v35
    s_mov_b64 exec, s[68:69]
    buffer_store_dwordx2 v[44:45], v24, s[28:31], s65 offen
    s_mov_b64 exec, -1
recurr_ep_32:
recurr_fin_15:
    s_cmp_eq_u32 s77, 0
    s_cbranch_scc1 recurr_dn_34
    ds_read2st64_b32 v[28:29], v125 offset0:0 offset1:20
    s_mov_b32 s71, 200000
    s_lshl_b32 s65, s61, 16
    s_waitcnt vmcnt(1)
recurr_pr_35:
    v_bitop3_b32 v30, v129, v131, s42 bitop3:0x7e
    v_bitop3_b32 v31, v133, v135, s42 bitop3:0x7e
    v_bitop3_b32 v32, v137, v139, s42 bitop3:0x7e
    v_bitop3_b32 v33, v141, v143, s42 bitop3:0x7e
    v_bitop3_b32 v34, v145, v147, s42 bitop3:0x7e
    v_bitop3_b32 v35, v149, v151, s42 bitop3:0x7e
    v_subrev_f32 v124, s65, v121
    v_or3_b32 v30, v30, v31, v32
    v_or3_b32 v33, v33, v34, v35
    v_cvt_pk_bf16_f32 v124, v124, v124
    v_or_b32 v30, v30, v33
    v_and_b32 v124, 0xffff0000, v124
    v_cmp_ne_u32 vcc, 0, v30
    v_mul_f32 v124, v124, v127
    s_cbranch_vccz recurr_po_36
    s_sub_u32 s71, s71, 1
    s_cbranch_scc1 recurr_po_36
    s_mul_i32 s64, s37, 5504
    s_add_u32 s64, s64, 6291456
    v_lshlrev_b32 v46, 4, v1
    buffer_load_dwordx4 v[128:131], v46, s[32:35], s64 offen offset:0 sc1
    buffer_load_dwordx4 v[132:135], v46, s[32:35], s64 offen offset:1024 sc1
    buffer_load_dwordx4 v[136:139], v46, s[32:35], s64 offen offset:2048 sc1
    buffer_load_dwordx4 v[140:143], v46, s[32:35], s64 offen offset:3072 sc1
    s_add_u32 s64, s64, 4096
    buffer_load_dwordx4 v[144:147], v46, s[32:35], s64 offen sc1
    s_mov_b64 exec, 0xffffff
    buffer_load_dwordx4 v[148:151], v46, s[32:35], s64 offen offset:1024 sc1
    s_mov_b64 exec, -1
    s_waitcnt vmcnt(0)
    s_branch recurr_pr_35
recurr_po_36:
    v_add_f32 v128, v128, v132
    v_add_f32 v130, v130, v134
    v_add_f32 v136, v136, v140
    v_add_f32 v138, v138, v142
    v_add_f32 v144, v144, v148
    v_add_f32 v146, v146, v150
    v_add_f32 v128, v128, v136
    v_add_f32 v130, v130, v138
    v_add_f32 v128, v128, v144
    v_add_f32 v130, v130, v146
    v_cvt_pk_bf16_f32 v124, v124, v124
    v_and_b32 v124, 0xffff0000, v124
    v_add_f32_dpp v30, v128, v128 row_ror:4 row_mask:0xf bank_mask:0x5
    s_nop 1
    v_add_f32_dpp v30, v130, v130 row_ror:4 row_mask:0xf bank_mask:0xa
    s_waitcnt lgkmcnt(0)
    v_add_f32 v28, v28, v29
    v_add_f32_dpp v30, v30, v30 quad_perm:[2,3,0,1] row_mask:0xf bank_mask:0xf
    v_fma_f32 v28, v124, v122, v28
    s_nop 0
    v_add_f32_dpp v30, v30, v30 row_ror:8 row_mask:0xf bank_mask:0xf
    v_mov_b32 v31, v30
    s_nop 1
    v_permlane32_swap_b32 v30, v31
    v_add_f32 v30, v30, v31
    v_mov_b32 v31, v30
    s_nop 1
    v_permlane16_swap_b32 v30, v31
    v_add_f32 v30, v30, v31
    v_cvt_pk_bf16_f32 v30, v30, v30
    v_and_b32 v30, 0xffff0000, v30
    v_mul_f32 v30, v30, v126
    v_cvt_pk_bf16_f32 v30, v30, v30
    v_and_b32 v30, 0xffff0000, v30
    v_add_f32 v30, v30, v124
    v_cvt_pk_bf16_f32 v30, v30, v30
    v_and_b32 v30, 0xffff0000, v30
    v_mul_f32 v31, s72, v30
    v_exp_f32 v31, v31
    v_mul_f32 v28, v28, v30
    v_add_f32 v31, 1.0, v31
    v_rcp_f32 v31, v31
    s_nop 0
    v_fma_f32 v28, v28, v31, v121
    v_cvt_pk_bf16_f32 v28, v28, v28
    s_mov_b64 exec, 0x33
    buffer_store_short v28, v123, s[28:31], 0 offen
    s_mov_b64 exec, -1
recurr_dn_34:
    s_waitcnt vmcnt(0)
END:
    s_endpgm

.section .rodata,"a"
.p2align 6
.amdhsa_kernel recurrent_scan__ssm_conv_s4d__moe_arch_mod__prompt_kernel
  .amdhsa_next_free_vgpr 256
  .amdhsa_next_free_sgpr 102
  .amdhsa_accum_offset 256
  .amdhsa_group_segment_fixed_size 0
  .amdhsa_kernarg_size 120
  .amdhsa_user_sgpr_count 2
  .amdhsa_user_sgpr_kernarg_segment_ptr 1
  .amdhsa_system_sgpr_workgroup_id_x 1
  .amdhsa_float_denorm_mode_32 3
.end_amdhsa_kernel
```
